```python
import torch

def _softmax(x, axis=-1):
    return torch.softmax(x, dim=axis)
def _gelu(x):
    return torch.nn.functional.gelu(x, approximate="tanh")
def _silu(x):
    return torch.nn.functional.silu(x)
def _sigmoid(x):
    return torch.sigmoid(x)
def _layernorm(x, axis=-1, eps=1e-5):
    m = x.mean(dim=axis, keepdim=True)
    v = x.var(dim=axis, keepdim=True, unbiased=False)
    return (x - m) / torch.sqrt(v + eps)
def _scatter_add(tgt, idx, src, axis=0):
    return tgt.clone().index_add_(axis, idx, src)
def _segment_sum(src, seg, n):
    out = torch.zeros((n,) + src.shape[1:], dtype=src.dtype)
    return out.index_add_(0, seg, src)
def _pad(x, pw):
    flat = tuple(v for pair in reversed(pw) for v in pair)
    return torch.nn.functional.pad(x, flat)

kernel_name = 'gated_mix__gqa_block_cached__dense_activation_silu__decode'

def setup_inputs():

    _w = (lambda a: (lambda t: t.to(torch.bfloat16) if t.is_floating_point() else t)(torch.as_tensor(a)))
    def _A_setup():
        B, Sq, D = 2, 1, 448
        Hq, Hkv, Sk, Dh = 16, 8, 32768, 256
        assert Hq % Hkv == 0, (Hq, Hkv)
        return {
            "x": _w((lambda *s: torch.randn(*s, dtype=torch.bfloat16) * 0.05)(B, Sq, D)),
            "k_cache": _w((lambda *s: torch.randn(*s, dtype=torch.bfloat16) * 6.4)(B, Hkv, Sk, Dh)),
            "v_cache": _w((lambda *s: torch.randn(*s, dtype=torch.bfloat16) * 0.8)(B, Hkv, Sk, Dh)),
            "wq": _w((lambda *s: torch.randn(*s, dtype=torch.bfloat16) * 6.4)(D, Hq * Dh) * (D ** -0.5)),
            "wo": _w((lambda *s: torch.randn(*s, dtype=torch.bfloat16) * 0.8)(Hq * Dh, D) * ((Hq * Dh) ** -0.5)),
        }
    _A_in = _A_setup()

    def _B_setup():
        B, S, D, F = 2, 1, 448, 1792
        return {
            "x": _w((lambda *s: torch.randn(*s, dtype=torch.bfloat16) * 0.05)(B, S, D)),
            "w1": _w((lambda *s: torch.randn(*s, dtype=torch.bfloat16) * 12.8)(D, F) * (D ** -0.5)),
            "w2": _w((lambda *s: torch.randn(*s, dtype=torch.bfloat16) * 0.2)(F, D) * (F ** -0.5)),
        }
    _B_in = _B_setup()

    return {
        "A_x": _A_in["x"],
        "A_k_cache": _A_in["k_cache"],
        "A_v_cache": _A_in["v_cache"],
        "A_wq": _A_in["wq"],
        "A_wo": _A_in["wo"],
        "B_x": _B_in["x"],
        "B_w1": _B_in["w1"],
        "B_w2": _B_in["w2"],
        "gate_w": _w((lambda *s: torch.randn(*s, dtype=torch.bfloat16) * 0.2)(448) * 16.0),
    }

def reference(A_x, A_k_cache, A_v_cache, A_wq, A_wo, B_x, B_w1, B_w2, gate_w):
    def _A_ref(x, k_cache, v_cache, wq, wo):
        B, Sq, D = x.shape
        Hq, Dh = 16, 256
        Hkv = k_cache.shape[1]
        rep = Hq // Hkv
        q = (lambda x, *d: x.permute(*d))((x @ wq).reshape(B, Sq, Hq, Dh), 0, 2, 1, 3)
        k = (lambda x, n, axis: torch.repeat_interleave(x, n, dim=axis))(k_cache, rep, axis=1)
        v = (lambda x, n, axis: torch.repeat_interleave(x, n, dim=axis))(v_cache, rep, axis=1)
        scores = torch.einsum("bhqd,bhkd->bhqk", q, k) * (Dh ** -0.5)
        p = _softmax(scores, axis=-1)
        o = torch.einsum("bhqk,bhkd->bhqd", p, v)
        return (lambda x, *d: x.permute(*d))(o, 0, 2, 1, 3).reshape(B, Sq, Hq * Dh) @ wo

    def _B_ref(x, w1, w2):
        h = torch.einsum("bsd,df->bsf", x, w1)
        h = _silu(h)
        out = torch.einsum("bsf,fd->bsd", h, w2)
        return out

    x = A_x
    g = _sigmoid((x * gate_w).sum(-1, keepdims=True))
    a = _A_ref(x, A_k_cache, A_v_cache, A_wq, A_wo)
    b = _B_ref(x, B_w1, B_w2)
    return g * a + (1 - g) * b
```

```asm
; @launch grid=(256,1,1) block=(256,1,1) lds=24448
.amdgcn_target "amdgcn-amd-amdhsa--gfx950"
.text
.globl gated_mix__gqa_block_cached__dense_activation_silu__decode_kernel
.p2align 8
.type gated_mix__gqa_block_cached__dense_activation_silu__decode_kernel,@function
gated_mix__gqa_block_cached__dense_activation_silu__decode_kernel:
  s_cmp_ge_u32 s2, 256
  s_cbranch_scc1 L_end
  s_load_dwordx2 s[44:45], s[0:1], 0
  s_load_dwordx2 s[48:49], s[0:1], 24
  s_load_dwordx2 s[32:33], s[0:1], 8
  s_load_dwordx2 s[40:41], s[0:1], 88
  s_load_dwordx2 s[36:37], s[0:1], 16
  s_load_dwordx16 s[4:19], s[0:1], 0
  s_load_dwordx8 s[20:27], s[0:1], 64
  v_lshrrev_b32 v2, 6, v0
  v_and_b32 v1, 63, v0
  v_readfirstlane_b32 s3, v2
  s_sub_u32 s3, s3, 1
  s_min_u32 s3, s3, 3
  s_lshr_b32 s28, s2, 4
  s_and_b32 s29, s2, 15
  s_lshr_b32 s30, s2, 7
  s_and_b32 s31, s2, 127
  s_and_b32 s64, s29, 7
  s_lshl_b32 s64, s64, 1
  s_lshr_b32 s65, s29, 3
  s_add_u32 s64, s64, s65
  s_andn2_b32 s65, s31, 15
  s_add_u32 s64, s64, s65
  v_and_b32 v8, 15, v1
  v_lshrrev_b32 v9, 4, v1
  v_and_b32 v10, 3, v1
  s_mov_b32 s42, 0x40000000
  s_mov_b32 s43, 0x00020000
  s_mul_i32 s58, s30, 896
  s_mov_b32 s46, 1792
  s_mov_b32 s47, 0x00020000
  s_mov_b32 s50, 3670016
  s_mov_b32 s51, 0x00020000
  v_lshrrev_b32 v14, 2, v1
  s_mul_i32 s57, s3, 14
  v_cmp_gt_u32 vcc, 14, v14
  v_add_u32 v14, s57, v14
  v_mov_b32 v13, 0x4000
  v_cndmask_b32 v14, v13, v14, vcc
  v_lshlrev_b32 v13, 16, v14
  v_lshl_add_u32 v13, v10, 4, v13
  v_lshlrev_b32 v14, 4, v14
  s_lshl_b32 s57, s64, 6
  v_lshlrev_b32 v12, 5, v10
  v_lshl_add_u32 v12, v9, 3, v12
  s_mov_b32 s60, 0x05040100
  s_mov_b32 s61, 0x07060302
  s_mov_b32 s62, 0x000f000f
  s_mov_b32 s63, 0x000f000f
  s_cmp_lg_u32 s3, 3
  s_cbranch_scc1 L_stream
  v_lshlrev_b32 v11, 5, v1
  s_lshl_b32 s56, s28, 11
  s_lshl_b32 s59, s30, 7
  s_add_u32 s59, s59, s64
  s_lshl_b32 s59, s59, 7
  s_waitcnt lgkmcnt(0)
  buffer_load_dwordx4 v[64:67], v11, s[40:43], s56 offen offset:0 sc1
  buffer_load_dwordx4 v[68:71], v11, s[40:43], s56 offen offset:16 sc1
  buffer_load_dwordx2 v[72:73], v12, s[40:43], s59 offen offset:0 sc1
  buffer_load_dwordx4 v[32:35], v14, s[44:47], s58 offen
  buffer_load_dwordx4 v[224:227], v13, s[48:51], s57 offen
  s_add_u32 s57, s57, 0x2000
  buffer_load_dwordx4 v[228:231], v13, s[48:51], s57 offen
  s_add_u32 s57, s57, 0x2000
  buffer_load_dwordx4 v[232:235], v13, s[48:51], s57 offen
  s_add_u32 s57, s57, 0x2000
  buffer_load_dwordx4 v[236:239], v13, s[48:51], s57 offen
  s_add_u32 s57, s57, 0x2000
  buffer_load_dwordx4 v[240:243], v13, s[48:51], s57 offen
  s_add_u32 s57, s57, 0x2000
  buffer_load_dwordx4 v[244:247], v13, s[48:51], s57 offen
  s_add_u32 s57, s57, 0x2000
  buffer_load_dwordx4 v[248:251], v13, s[48:51], s57 offen
  s_add_u32 s57, s57, 0x2000
  buffer_load_dwordx4 v[252:255], v13, s[48:51], s57 offen
  s_branch L_service
L_stream:
  s_mov_b32 s34, 0x10000000
  s_mov_b32 s35, 0x00020000
  s_mov_b32 s38, 0x10000000
  s_mov_b32 s39, 0x00020000
  s_lshl_b32 s56, s28, 24
  s_and_b32 s66, s29, 7
  s_lshl_b32 s66, s66, 21
  s_or_b32 s56, s56, s66
  s_lshr_b32 s66, s29, 3
  s_lshl_b32 s66, s66, 15
  s_or_b32 s56, s56, s66
  s_lshl_b32 s67, s3, 13
  s_or_b32 s56, s56, s67
  v_lshrrev_b32 v3, 2, v8
  v_lshlrev_b32 v2, 11, v3
  v_lshl_add_u32 v2, v9, 6, v2
  v_lshl_add_u32 v2, v10, 4, v2
  v_lshlrev_b32 v3, 11, v9
  v_lshl_add_u32 v3, v8, 4, v3
  s_waitcnt lgkmcnt(0)
  buffer_load_dwordx4 v[32:35], v14, s[44:47], s58 offen
  buffer_load_dwordx4 v[224:227], v13, s[48:51], s57 offen
  s_add_u32 s57, s57, 0x2000
  buffer_load_dwordx4 v[228:231], v13, s[48:51], s57 offen
  s_add_u32 s57, s57, 0x2000
  buffer_load_dwordx4 v[232:235], v13, s[48:51], s57 offen
  s_add_u32 s57, s57, 0x2000
  buffer_load_dwordx4 v[236:239], v13, s[48:51], s57 offen
  s_add_u32 s57, s57, 0x2000
  buffer_load_dwordx4 v[240:243], v13, s[48:51], s57 offen
  s_add_u32 s57, s57, 0x2000
  buffer_load_dwordx4 v[244:247], v13, s[48:51], s57 offen
  s_add_u32 s57, s57, 0x2000
  buffer_load_dwordx4 v[248:251], v13, s[48:51], s57 offen
  s_add_u32 s57, s57, 0x2000
  buffer_load_dwordx4 v[252:255], v13, s[48:51], s57 offen
  s_mov_b32 s57, s56
  buffer_load_dwordx4 v[64:67], v2, s[32:35], s57 offen offset:0 nt
  buffer_load_dwordx4 v[68:71], v2, s[32:35], s57 offen offset:256 nt
  buffer_load_dwordx4 v[72:75], v2, s[32:35], s57 offen offset:512 nt
  buffer_load_dwordx4 v[76:79], v2, s[32:35], s57 offen offset:768 nt
  buffer_load_dwordx4 v[80:83], v2, s[32:35], s57 offen offset:1024 nt
  buffer_load_dwordx4 v[84:87], v2, s[32:35], s57 offen offset:1280 nt
  buffer_load_dwordx4 v[88:91], v2, s[32:35], s57 offen offset:1536 nt
  buffer_load_dwordx4 v[92:95], v2, s[32:35], s57 offen offset:1792 nt
  s_or_b32 s57, s57, 0x8000
  s_add_u32 s57, s57, 0x6000
  s_andn2_b32 s57, s57, 0x8000
  s_or_b32 s57, s57, s66
  v_mov_b32 v16, 0
  v_mov_b32 v17, 0
  v_mov_b32 v18, 0
  v_mov_b32 v19, 0
  v_mov_b32 v20, 0
  v_mov_b32 v21, 0
  v_mov_b32 v22, 0
  v_mov_b32 v23, 0
  s_lshl_b32 s58, s3, 7
  v_add_u32 v13, s58, v12
  s_waitcnt vmcnt(14)
  v_perm_b32 v52, v228, v224, s60
  v_perm_b32 v56, v228, v224, s61
  v_perm_b32 v53, v229, v225, s60
  v_perm_b32 v57, v229, v225, s61
  v_perm_b32 v54, v230, v226, s60
  v_perm_b32 v58, v230, v226, s61
  v_perm_b32 v55, v231, v227, s60
  v_perm_b32 v59, v231, v227, s61
  v_dot2c_f32_bf16 v16, v52, v32
  v_dot2c_f32_bf16 v17, v56, v32
  v_dot2c_f32_bf16 v18, v53, v32
  v_dot2c_f32_bf16 v19, v57, v32
  v_dot2c_f32_bf16 v20, v54, v32
  v_dot2c_f32_bf16 v21, v58, v32
  v_dot2c_f32_bf16 v22, v55, v32
  v_dot2c_f32_bf16 v23, v59, v32
  s_waitcnt vmcnt(12)
  v_perm_b32 v52, v236, v232, s60
  v_perm_b32 v56, v236, v232, s61
  v_perm_b32 v53, v237, v233, s60
  v_perm_b32 v57, v237, v233, s61
  v_perm_b32 v54, v238, v234, s60
  v_perm_b32 v58, v238, v234, s61
  v_perm_b32 v55, v239, v235, s60
  v_perm_b32 v59, v239, v235, s61
  v_dot2c_f32_bf16 v16, v52, v33
  v_dot2c_f32_bf16 v17, v56, v33
  v_dot2c_f32_bf16 v18, v53, v33
  v_dot2c_f32_bf16 v19, v57, v33
  v_dot2c_f32_bf16 v20, v54, v33
  v_dot2c_f32_bf16 v21, v58, v33
  v_dot2c_f32_bf16 v22, v55, v33
  v_dot2c_f32_bf16 v23, v59, v33
  s_waitcnt vmcnt(10)
  v_perm_b32 v52, v244, v240, s60
  v_perm_b32 v56, v244, v240, s61
  v_perm_b32 v53, v245, v241, s60
  v_perm_b32 v57, v245, v241, s61
  v_perm_b32 v54, v246, v242, s60
  v_perm_b32 v58, v246, v242, s61
  v_perm_b32 v55, v247, v243, s60
  v_perm_b32 v59, v247, v243, s61
  v_dot2c_f32_bf16 v16, v52, v34
  v_dot2c_f32_bf16 v17, v56, v34
  v_dot2c_f32_bf16 v18, v53, v34
  v_dot2c_f32_bf16 v19, v57, v34
  v_dot2c_f32_bf16 v20, v54, v34
  v_dot2c_f32_bf16 v21, v58, v34
  v_dot2c_f32_bf16 v22, v55, v34
  v_dot2c_f32_bf16 v23, v59, v34
  s_waitcnt vmcnt(8)
  v_perm_b32 v52, v252, v248, s60
  v_perm_b32 v56, v252, v248, s61
  v_perm_b32 v53, v253, v249, s60
  v_perm_b32 v57, v253, v249, s61
  v_perm_b32 v54, v254, v250, s60
  v_perm_b32 v58, v254, v250, s61
  v_perm_b32 v55, v255, v251, s60
  v_perm_b32 v59, v255, v251, s61
  v_dot2c_f32_bf16 v16, v52, v35
  v_dot2c_f32_bf16 v17, v56, v35
  v_dot2c_f32_bf16 v18, v53, v35
  v_dot2c_f32_bf16 v19, v57, v35
  v_dot2c_f32_bf16 v20, v54, v35
  v_dot2c_f32_bf16 v21, v58, v35
  v_dot2c_f32_bf16 v22, v55, v35
  v_dot2c_f32_bf16 v23, v59, v35
  s_nop 3
  v_permlane32_swap_b32 v16, v20
  v_permlane32_swap_b32 v17, v21
  v_permlane32_swap_b32 v18, v22
  v_permlane32_swap_b32 v19, v23
  s_nop 1
  v_add_f32 v16, v16, v20
  v_add_f32 v17, v17, v21
  v_add_f32 v18, v18, v22
  v_add_f32 v19, v19, v23
  s_nop 1
  v_permlane16_swap_b32 v16, v18
  v_permlane16_swap_b32 v17, v19
  s_nop 1
  v_add_f32 v16, v16, v18
  v_add_f32 v17, v17, v19
  s_nop 1
  v_add_f32_dpp v16, v16, v16 row_ror:8 row_mask:0xf bank_mask:0xf
  v_add_f32_dpp v17, v17, v17 row_ror:8 row_mask:0xf bank_mask:0xf
  s_nop 1
  v_add_f32_dpp v16, v16, v16 row_ror:4 row_mask:0xf bank_mask:0xf
  v_add_f32_dpp v17, v17, v17 row_ror:4 row_mask:0xf bank_mask:0xf
  s_mov_b64 exec, s[62:63]
  ds_write_b64 v13, v[16:17] offset:22848
  s_mov_b64 exec, -1
  s_waitcnt lgkmcnt(0)
  s_barrier
  s_waitcnt vmcnt(0)
  buffer_load_dwordx4 v[96:99], v2, s[32:35], s57 offen offset:0 nt
  buffer_load_dwordx4 v[100:103], v2, s[32:35], s57 offen offset:256 nt
  buffer_load_dwordx4 v[104:107], v2, s[32:35], s57 offen offset:512 nt
  buffer_load_dwordx4 v[108:111], v2, s[32:35], s57 offen offset:768 nt
  buffer_load_dwordx4 v[112:115], v2, s[32:35], s57 offen offset:1024 nt
  buffer_load_dwordx4 v[116:119], v2, s[32:35], s57 offen offset:1280 nt
  buffer_load_dwordx4 v[120:123], v2, s[32:35], s57 offen offset:1536 nt
  buffer_load_dwordx4 v[124:127], v2, s[32:35], s57 offen offset:1792 nt
  s_or_b32 s57, s57, 0x8000
  s_add_u32 s57, s57, 0x6000
  s_andn2_b32 s57, s57, 0x8000
  s_or_b32 s57, s57, s66
  v_bfe_u32 v12, v1, 3, 1
  v_lshlrev_b32 v13, 2, v12
  v_add_u32 v13, v13, v9
  v_lshlrev_b32 v12, 9, v12
  v_lshl_add_u32 v12, v9, 6, v12
  v_lshl_add_u32 v12, v10, 4, v12
  s_mul_i32 s58, s3, 5120
  s_add_u32 s58, s58, 1024
  v_lshlrev_b32 v13, 4, v13
  v_add_u32 v13, s58, v13
  v_and_b32 v56, 1, v1
  v_lshlrev_b32 v56, 4, v56
  v_mov_b32 v57, 0xffff
  v_lshlrev_b32 v57, v56, v57
  v_bfe_u32 v56, v1, 1, 2
  v_cmp_eq_u32 vcc, 0, v56
  s_nop 1
  v_cndmask_b32 v4, 0, v57, vcc
  v_cmp_eq_u32 vcc, 1, v56
  s_nop 1
  v_cndmask_b32 v5, 0, v57, vcc
  v_cmp_eq_u32 vcc, 2, v56
  s_nop 1
  v_cndmask_b32 v6, 0, v57, vcc
  v_cmp_eq_u32 vcc, 3, v56
  s_nop 1
  v_cndmask_b32 v7, 0, v57, vcc
  v_mov_b32 v14, 0xff800000
  v_mov_b32 v15, 0
  v_mov_b32 v24, 0
  v_mov_b32 v25, 0
  v_mov_b32 v26, 0
  v_mov_b32 v27, 0
  v_mov_b32 v28, 0
  v_mov_b32 v29, 0
  v_mov_b32 v30, 0
  v_mov_b32 v31, 0
  s_mov_b32 s59, 0x3db8aa3b
  s_waitcnt vmcnt(0)
  buffer_load_dwordx4 v[128:131], v2, s[32:35], s57 offen offset:0 nt
  buffer_load_dwordx4 v[132:135], v2, s[32:35], s57 offen offset:256 nt
  buffer_load_dwordx4 v[136:139], v2, s[32:35], s57 offen offset:512 nt
  buffer_load_dwordx4 v[140:143], v2, s[32:35], s57 offen offset:768 nt
  buffer_load_dwordx4 v[144:147], v2, s[32:35], s57 offen offset:1024 nt
  buffer_load_dwordx4 v[148:151], v2, s[32:35], s57 offen offset:1280 nt
  buffer_load_dwordx4 v[152:155], v2, s[32:35], s57 offen offset:1536 nt
  buffer_load_dwordx4 v[156:159], v2, s[32:35], s57 offen offset:1792 nt
  s_or_b32 s57, s57, 0x8000
  s_add_u32 s57, s57, 0x6000
  s_andn2_b32 s57, s57, 0x8000
  s_or_b32 s57, s57, s66
  s_waitcnt vmcnt(0)
  buffer_load_dwordx4 v[160:163], v2, s[32:35], s57 offen offset:0 nt
  buffer_load_dwordx4 v[164:167], v2, s[32:35], s57 offen offset:256 nt
  buffer_load_dwordx4 v[168:171], v2, s[32:35], s57 offen offset:512 nt
  buffer_load_dwordx4 v[172:175], v2, s[32:35], s57 offen offset:768 nt
  buffer_load_dwordx4 v[176:179], v2, s[32:35], s57 offen offset:1024 nt
  buffer_load_dwordx4 v[180:183], v2, s[32:35], s57 offen offset:1280 nt
  buffer_load_dwordx4 v[184:187], v2, s[32:35], s57 offen offset:1536 nt
  buffer_load_dwordx4 v[188:191], v2, s[32:35], s57 offen offset:1792 nt
  s_or_b32 s57, s57, 0x8000
  s_add_u32 s57, s57, 0x6000
  s_andn2_b32 s57, s57, 0x8000
  s_or_b32 s57, s57, s66
  s_waitcnt vmcnt(0)
  buffer_load_dwordx4 v[192:195], v2, s[32:35], s57 offen offset:0 nt
  buffer_load_dwordx4 v[196:199], v2, s[32:35], s57 offen offset:256 nt
  buffer_load_dwordx4 v[200:203], v2, s[32:35], s57 offen offset:512 nt
  buffer_load_dwordx4 v[204:207], v2, s[32:35], s57 offen offset:768 nt
  buffer_load_dwordx4 v[208:211], v2, s[32:35], s57 offen offset:1024 nt
  buffer_load_dwordx4 v[212:215], v2, s[32:35], s57 offen offset:1280 nt
  buffer_load_dwordx4 v[216:219], v2, s[32:35], s57 offen offset:1536 nt
  buffer_load_dwordx4 v[220:223], v2, s[32:35], s57 offen offset:1792 nt
  s_or_b32 s57, s57, 0x8000
  s_add_u32 s57, s57, 0x6000
  s_andn2_b32 s57, s57, 0x8000
  s_or_b32 s57, s57, s66
  s_waitcnt vmcnt(0)
  buffer_load_dwordx4 v[224:227], v2, s[32:35], s57 offen offset:0 nt
  buffer_load_dwordx4 v[228:231], v2, s[32:35], s57 offen offset:256 nt
  buffer_load_dwordx4 v[232:235], v2, s[32:35], s57 offen offset:512 nt
  buffer_load_dwordx4 v[236:239], v2, s[32:35], s57 offen offset:768 nt
  buffer_load_dwordx4 v[240:243], v2, s[32:35], s57 offen offset:1024 nt
  buffer_load_dwordx4 v[244:247], v2, s[32:35], s57 offen offset:1280 nt
  buffer_load_dwordx4 v[248:251], v2, s[32:35], s57 offen offset:1536 nt
  buffer_load_dwordx4 v[252:255], v2, s[32:35], s57 offen offset:1792 nt
  s_or_b32 s57, s57, 0x8000
  s_add_u32 s57, s57, 0x6000
  s_andn2_b32 s57, s57, 0x8000
  s_or_b32 s57, s57, s66
  s_barrier
  ds_read_b128 v[16:19], v12 offset:0
  ds_read_b128 v[20:23], v12 offset:256
  s_waitcnt lgkmcnt(0)
  s_waitcnt vmcnt(40)
  v_mfma_f32_16x16x32_bf16 v[32:35], v[64:67], v[16:19], 0
  v_mfma_f32_16x16x32_bf16 v[32:35], v[68:71], v[20:23], v[32:35]
  v_mfma_f32_16x16x32_bf16 v[36:39], v[72:75], v[16:19], 0
  v_mfma_f32_16x16x32_bf16 v[36:39], v[76:79], v[20:23], v[36:39]
  v_mfma_f32_16x16x32_bf16 v[40:43], v[80:83], v[16:19], 0
  v_mfma_f32_16x16x32_bf16 v[40:43], v[84:87], v[20:23], v[40:43]
  v_mfma_f32_16x16x32_bf16 v[44:47], v[88:91], v[16:19], 0
  v_mfma_f32_16x16x32_bf16 v[44:47], v[92:95], v[20:23], v[44:47]
  buffer_load_dwordx4 v[64:67], v2, s[32:35], s57 offen offset:0 nt
  buffer_load_dwordx4 v[68:71], v2, s[32:35], s57 offen offset:256 nt
  buffer_load_dwordx4 v[72:75], v2, s[32:35], s57 offen offset:512 nt
  buffer_load_dwordx4 v[76:79], v2, s[32:35], s57 offen offset:768 nt
  buffer_load_dwordx4 v[80:83], v2, s[32:35], s57 offen offset:1024 nt
  buffer_load_dwordx4 v[84:87], v2, s[32:35], s57 offen offset:1280 nt
  buffer_load_dwordx4 v[88:91], v2, s[32:35], s57 offen offset:1536 nt
  buffer_load_dwordx4 v[92:95], v2, s[32:35], s57 offen offset:1792 nt
  s_or_b32 s57, s57, 0x8000
  s_add_u32 s57, s57, 0x6000
  s_andn2_b32 s57, s57, 0x8000
  s_or_b32 s57, s57, s66
  v_mov_b32_dpp v48, v32 quad_perm:[0,0,0,0] row_mask:0xf bank_mask:0xf
  v_mov_b32_dpp v49, v36 quad_perm:[0,0,0,0] row_mask:0xf bank_mask:0xf
  v_mov_b32_dpp v50, v40 quad_perm:[0,0,0,0] row_mask:0xf bank_mask:0xf
  v_mov_b32_dpp v51, v44 quad_perm:[0,0,0,0] row_mask:0xf bank_mask:0xf
  v_add_f32_dpp v48, v33, v48 quad_perm:[1,1,1,1] row_mask:0xf bank_mask:0xf
  v_add_f32_dpp v49, v37, v49 quad_perm:[1,1,1,1] row_mask:0xf bank_mask:0xf
  v_add_f32_dpp v50, v41, v50 quad_perm:[1,1,1,1] row_mask:0xf bank_mask:0xf
  v_add_f32_dpp v51, v45, v51 quad_perm:[1,1,1,1] row_mask:0xf bank_mask:0xf
  v_add_f32_dpp v48, v34, v48 quad_perm:[2,2,2,2] row_mask:0xf bank_mask:0xf
  v_add_f32_dpp v49, v38, v49 quad_perm:[2,2,2,2] row_mask:0xf bank_mask:0xf
  v_add_f32_dpp v50, v42, v50 quad_perm:[2,2,2,2] row_mask:0xf bank_mask:0xf
  v_add_f32_dpp v51, v46, v51 quad_perm:[2,2,2,2] row_mask:0xf bank_mask:0xf
  v_add_f32_dpp v48, v35, v48 quad_perm:[3,3,3,3] row_mask:0xf bank_mask:0xf
  v_add_f32_dpp v49, v39, v49 quad_perm:[3,3,3,3] row_mask:0xf bank_mask:0xf
  v_add_f32_dpp v50, v43, v50 quad_perm:[3,3,3,3] row_mask:0xf bank_mask:0xf
  v_add_f32_dpp v51, v47, v51 quad_perm:[3,3,3,3] row_mask:0xf bank_mask:0xf
  v_cvt_pk_bf16_f32 v48, 0, v48
  v_cvt_pk_bf16_f32 v49, 0, v49
  v_cvt_pk_bf16_f32 v50, 0, v50
  v_cvt_pk_bf16_f32 v51, 0, v51
  v_max3_f32 v14, v14, v48, v49
  v_max3_f32 v14, v14, v50, v51
  ds_write_b128 v13, v[48:51] offset:0
  s_waitcnt vmcnt(40)
  v_mfma_f32_16x16x32_bf16 v[32:35], v[96:99], v[16:19], 0
  v_mfma_f32_16x16x32_bf16 v[32:35], v[100:103], v[20:23], v[32:35]
  v_mfma_f32_16x16x32_bf16 v[36:39], v[104:107], v[16:19], 0
  v_mfma_f32_16x16x32_bf16 v[36:39], v[108:111], v[20:23], v[36:39]
  v_mfma_f32_16x16x32_bf16 v[40:43], v[112:115], v[16:19], 0
  v_mfma_f32_16x16x32_bf16 v[40:43], v[116:119], v[20:23], v[40:43]
  v_mfma_f32_16x16x32_bf16 v[44:47], v[120:123], v[16:19], 0
  v_mfma_f32_16x16x32_bf16 v[44:47], v[124:127], v[20:23], v[44:47]
  s_nop 4
  v_mov_b32_dpp v48, v32 quad_perm:[0,0,0,0] row_mask:0xf bank_mask:0xf
  v_mov_b32_dpp v49, v36 quad_perm:[0,0,0,0] row_mask:0xf bank_mask:0xf
  v_mov_b32_dpp v50, v40 quad_perm:[0,0,0,0] row_mask:0xf bank_mask:0xf
  v_mov_b32_dpp v51, v44 quad_perm:[0,0,0,0] row_mask:0xf bank_mask:0xf
  v_add_f32_dpp v48, v33, v48 quad_perm:[1,1,1,1] row_mask:0xf bank_mask:0xf
  v_add_f32_dpp v49, v37, v49 quad_perm:[1,1,1,1] row_mask:0xf bank_mask:0xf
  v_add_f32_dpp v50, v41, v50 quad_perm:[1,1,1,1] row_mask:0xf bank_mask:0xf
  v_add_f32_dpp v51, v45, v51 quad_perm:[1,1,1,1] row_mask:0xf bank_mask:0xf
  v_add_f32_dpp v48, v34, v48 quad_perm:[2,2,2,2] row_mask:0xf bank_mask:0xf
  v_add_f32_dpp v49, v38, v49 quad_perm:[2,2,2,2] row_mask:0xf bank_mask:0xf
  v_add_f32_dpp v50, v42, v50 quad_perm:[2,2,2,2] row_mask:0xf bank_mask:0xf
  v_add_f32_dpp v51, v46, v51 quad_perm:[2,2,2,2] row_mask:0xf bank_mask:0xf
  v_add_f32_dpp v48, v35, v48 quad_perm:[3,3,3,3] row_mask:0xf bank_mask:0xf
  v_add_f32_dpp v49, v39, v49 quad_perm:[3,3,3,3] row_mask:0xf bank_mask:0xf
  v_add_f32_dpp v50, v43, v50 quad_perm:[3,3,3,3] row_mask:0xf bank_mask:0xf
  v_add_f32_dpp v51, v47, v51 quad_perm:[3,3,3,3] row_mask:0xf bank_mask:0xf
  v_cvt_pk_bf16_f32 v48, 0, v48
  v_cvt_pk_bf16_f32 v49, 0, v49
  v_cvt_pk_bf16_f32 v50, 0, v50
  v_cvt_pk_bf16_f32 v51, 0, v51
  v_max3_f32 v14, v14, v48, v49
  v_max3_f32 v14, v14, v50, v51
  ds_write_b128 v13, v[48:51] offset:128
  s_waitcnt vmcnt(32)
  v_mfma_f32_16x16x32_bf16 v[32:35], v[128:131], v[16:19], 0
  v_mfma_f32_16x16x32_bf16 v[32:35], v[132:135], v[20:23], v[32:35]
  v_mfma_f32_16x16x32_bf16 v[36:39], v[136:139], v[16:19], 0
  v_mfma_f32_16x16x32_bf16 v[36:39], v[140:143], v[20:23], v[36:39]
  v_mfma_f32_16x16x32_bf16 v[40:43], v[144:147], v[16:19], 0
  v_mfma_f32_16x16x32_bf16 v[40:43], v[148:151], v[20:23], v[40:43]
  v_mfma_f32_16x16x32_bf16 v[44:47], v[152:155], v[16:19], 0
  v_mfma_f32_16x16x32_bf16 v[44:47], v[156:159], v[20:23], v[44:47]
  s_nop 4
  v_mov_b32_dpp v48, v32 quad_perm:[0,0,0,0] row_mask:0xf bank_mask:0xf
  v_mov_b32_dpp v49, v36 quad_perm:[0,0,0,0] row_mask:0xf bank_mask:0xf
  v_mov_b32_dpp v50, v40 quad_perm:[0,0,0,0] row_mask:0xf bank_mask:0xf
  v_mov_b32_dpp v51, v44 quad_perm:[0,0,0,0] row_mask:0xf bank_mask:0xf
  v_add_f32_dpp v48, v33, v48 quad_perm:[1,1,1,1] row_mask:0xf bank_mask:0xf
  v_add_f32_dpp v49, v37, v49 quad_perm:[1,1,1,1] row_mask:0xf bank_mask:0xf
  v_add_f32_dpp v50, v41, v50 quad_perm:[1,1,1,1] row_mask:0xf bank_mask:0xf
  v_add_f32_dpp v51, v45, v51 quad_perm:[1,1,1,1] row_mask:0xf bank_mask:0xf
  v_add_f32_dpp v48, v34, v48 quad_perm:[2,2,2,2] row_mask:0xf bank_mask:0xf
  v_add_f32_dpp v49, v38, v49 quad_perm:[2,2,2,2] row_mask:0xf bank_mask:0xf
  v_add_f32_dpp v50, v42, v50 quad_perm:[2,2,2,2] row_mask:0xf bank_mask:0xf
  v_add_f32_dpp v51, v46, v51 quad_perm:[2,2,2,2] row_mask:0xf bank_mask:0xf
  v_add_f32_dpp v48, v35, v48 quad_perm:[3,3,3,3] row_mask:0xf bank_mask:0xf
  v_add_f32_dpp v49, v39, v49 quad_perm:[3,3,3,3] row_mask:0xf bank_mask:0xf
  v_add_f32_dpp v50, v43, v50 quad_perm:[3,3,3,3] row_mask:0xf bank_mask:0xf
  v_add_f32_dpp v51, v47, v51 quad_perm:[3,3,3,3] row_mask:0xf bank_mask:0xf
  v_cvt_pk_bf16_f32 v48, 0, v48
  v_cvt_pk_bf16_f32 v49, 0, v49
  v_cvt_pk_bf16_f32 v50, 0, v50
  v_cvt_pk_bf16_f32 v51, 0, v51
  v_max3_f32 v14, v14, v48, v49
  v_max3_f32 v14, v14, v50, v51
  ds_write_b128 v13, v[48:51] offset:256
  s_waitcnt vmcnt(24)
  v_mfma_f32_16x16x32_bf16 v[32:35], v[160:163], v[16:19], 0
  v_mfma_f32_16x16x32_bf16 v[32:35], v[164:167], v[20:23], v[32:35]
  v_mfma_f32_16x16x32_bf16 v[36:39], v[168:171], v[16:19], 0
  v_mfma_f32_16x16x32_bf16 v[36:39], v[172:175], v[20:23], v[36:39]
  v_mfma_f32_16x16x32_bf16 v[40:43], v[176:179], v[16:19], 0
  v_mfma_f32_16x16x32_bf16 v[40:43], v[180:183], v[20:23], v[40:43]
  v_mfma_f32_16x16x32_bf16 v[44:47], v[184:187], v[16:19], 0
  v_mfma_f32_16x16x32_bf16 v[44:47], v[188:191], v[20:23], v[44:47]
  s_nop 4
  v_mov_b32_dpp v48, v32 quad_perm:[0,0,0,0] row_mask:0xf bank_mask:0xf
  v_mov_b32_dpp v49, v36 quad_perm:[0,0,0,0] row_mask:0xf bank_mask:0xf
  v_mov_b32_dpp v50, v40 quad_perm:[0,0,0,0] row_mask:0xf bank_mask:0xf
  v_mov_b32_dpp v51, v44 quad_perm:[0,0,0,0] row_mask:0xf bank_mask:0xf
  v_add_f32_dpp v48, v33, v48 quad_perm:[1,1,1,1] row_mask:0xf bank_mask:0xf
  v_add_f32_dpp v49, v37, v49 quad_perm:[1,1,1,1] row_mask:0xf bank_mask:0xf
  v_add_f32_dpp v50, v41, v50 quad_perm:[1,1,1,1] row_mask:0xf bank_mask:0xf
  v_add_f32_dpp v51, v45, v51 quad_perm:[1,1,1,1] row_mask:0xf bank_mask:0xf
  v_add_f32_dpp v48, v34, v48 quad_perm:[2,2,2,2] row_mask:0xf bank_mask:0xf
  v_add_f32_dpp v49, v38, v49 quad_perm:[2,2,2,2] row_mask:0xf bank_mask:0xf
  v_add_f32_dpp v50, v42, v50 quad_perm:[2,2,2,2] row_mask:0xf bank_mask:0xf
  v_add_f32_dpp v51, v46, v51 quad_perm:[2,2,2,2] row_mask:0xf bank_mask:0xf
  v_add_f32_dpp v48, v35, v48 quad_perm:[3,3,3,3] row_mask:0xf bank_mask:0xf
  v_add_f32_dpp v49, v39, v49 quad_perm:[3,3,3,3] row_mask:0xf bank_mask:0xf
  v_add_f32_dpp v50, v43, v50 quad_perm:[3,3,3,3] row_mask:0xf bank_mask:0xf
  v_add_f32_dpp v51, v47, v51 quad_perm:[3,3,3,3] row_mask:0xf bank_mask:0xf
  v_cvt_pk_bf16_f32 v48, 0, v48
  v_cvt_pk_bf16_f32 v49, 0, v49
  v_cvt_pk_bf16_f32 v50, 0, v50
  v_cvt_pk_bf16_f32 v51, 0, v51
  v_max3_f32 v14, v14, v48, v49
  v_max3_f32 v14, v14, v50, v51
  ds_write_b128 v13, v[48:51] offset:384
  s_waitcnt vmcnt(16)
  v_mfma_f32_16x16x32_bf16 v[32:35], v[192:195], v[16:19], 0
  v_mfma_f32_16x16x32_bf16 v[32:35], v[196:199], v[20:23], v[32:35]
  v_mfma_f32_16x16x32_bf16 v[36:39], v[200:203], v[16:19], 0
  v_mfma_f32_16x16x32_bf16 v[36:39], v[204:207], v[20:23], v[36:39]
  v_mfma_f32_16x16x32_bf16 v[40:43], v[208:211], v[16:19], 0
  v_mfma_f32_16x16x32_bf16 v[40:43], v[212:215], v[20:23], v[40:43]
  v_mfma_f32_16x16x32_bf16 v[44:47], v[216:219], v[16:19], 0
  v_mfma_f32_16x16x32_bf16 v[44:47], v[220:223], v[20:23], v[44:47]
  s_nop 4
  v_mov_b32_dpp v48, v32 quad_perm:[0,0,0,0] row_mask:0xf bank_mask:0xf
  v_mov_b32_dpp v49, v36 quad_perm:[0,0,0,0] row_mask:0xf bank_mask:0xf
  v_mov_b32_dpp v50, v40 quad_perm:[0,0,0,0] row_mask:0xf bank_mask:0xf
  v_mov_b32_dpp v51, v44 quad_perm:[0,0,0,0] row_mask:0xf bank_mask:0xf
  v_add_f32_dpp v48, v33, v48 quad_perm:[1,1,1,1] row_mask:0xf bank_mask:0xf
  v_add_f32_dpp v49, v37, v49 quad_perm:[1,1,1,1] row_mask:0xf bank_mask:0xf
  v_add_f32_dpp v50, v41, v50 quad_perm:[1,1,1,1] row_mask:0xf bank_mask:0xf
  v_add_f32_dpp v51, v45, v51 quad_perm:[1,1,1,1] row_mask:0xf bank_mask:0xf
  v_add_f32_dpp v48, v34, v48 quad_perm:[2,2,2,2] row_mask:0xf bank_mask:0xf
  v_add_f32_dpp v49, v38, v49 quad_perm:[2,2,2,2] row_mask:0xf bank_mask:0xf
  v_add_f32_dpp v50, v42, v50 quad_perm:[2,2,2,2] row_mask:0xf bank_mask:0xf
  v_add_f32_dpp v51, v46, v51 quad_perm:[2,2,2,2] row_mask:0xf bank_mask:0xf
  v_add_f32_dpp v48, v35, v48 quad_perm:[3,3,3,3] row_mask:0xf bank_mask:0xf
  v_add_f32_dpp v49, v39, v49 quad_perm:[3,3,3,3] row_mask:0xf bank_mask:0xf
  v_add_f32_dpp v50, v43, v50 quad_perm:[3,3,3,3] row_mask:0xf bank_mask:0xf
  v_add_f32_dpp v51, v47, v51 quad_perm:[3,3,3,3] row_mask:0xf bank_mask:0xf
  v_cvt_pk_bf16_f32 v48, 0, v48
  v_cvt_pk_bf16_f32 v49, 0, v49
  v_cvt_pk_bf16_f32 v50, 0, v50
  v_cvt_pk_bf16_f32 v51, 0, v51
  v_max3_f32 v14, v14, v48, v49
  v_max3_f32 v14, v14, v50, v51
  ds_write_b128 v13, v[48:51] offset:512
  s_waitcnt vmcnt(8)
  v_mfma_f32_16x16x32_bf16 v[32:35], v[224:227], v[16:19], 0
  v_mfma_f32_16x16x32_bf16 v[32:35], v[228:231], v[20:23], v[32:35]
  v_mfma_f32_16x16x32_bf16 v[36:39], v[232:235], v[16:19], 0
  v_mfma_f32_16x16x32_bf16 v[36:39], v[236:239], v[20:23], v[36:39]
  v_mfma_f32_16x16x32_bf16 v[40:43], v[240:243], v[16:19], 0
  v_mfma_f32_16x16x32_bf16 v[40:43], v[244:247], v[20:23], v[40:43]
  v_mfma_f32_16x16x32_bf16 v[44:47], v[248:251], v[16:19], 0
  v_mfma_f32_16x16x32_bf16 v[44:47], v[252:255], v[20:23], v[44:47]
  s_nop 4
  v_mov_b32_dpp v48, v32 quad_perm:[0,0,0,0] row_mask:0xf bank_mask:0xf
  v_mov_b32_dpp v49, v36 quad_perm:[0,0,0,0] row_mask:0xf bank_mask:0xf
  v_mov_b32_dpp v50, v40 quad_perm:[0,0,0,0] row_mask:0xf bank_mask:0xf
  v_mov_b32_dpp v51, v44 quad_perm:[0,0,0,0] row_mask:0xf bank_mask:0xf
  v_add_f32_dpp v48, v33, v48 quad_perm:[1,1,1,1] row_mask:0xf bank_mask:0xf
  v_add_f32_dpp v49, v37, v49 quad_perm:[1,1,1,1] row_mask:0xf bank_mask:0xf
  v_add_f32_dpp v50, v41, v50 quad_perm:[1,1,1,1] row_mask:0xf bank_mask:0xf
  v_add_f32_dpp v51, v45, v51 quad_perm:[1,1,1,1] row_mask:0xf bank_mask:0xf
  v_add_f32_dpp v48, v34, v48 quad_perm:[2,2,2,2] row_mask:0xf bank_mask:0xf
  v_add_f32_dpp v49, v38, v49 quad_perm:[2,2,2,2] row_mask:0xf bank_mask:0xf
  v_add_f32_dpp v50, v42, v50 quad_perm:[2,2,2,2] row_mask:0xf bank_mask:0xf
  v_add_f32_dpp v51, v46, v51 quad_perm:[2,2,2,2] row_mask:0xf bank_mask:0xf
  v_add_f32_dpp v48, v35, v48 quad_perm:[3,3,3,3] row_mask:0xf bank_mask:0xf
  v_add_f32_dpp v49, v39, v49 quad_perm:[3,3,3,3] row_mask:0xf bank_mask:0xf
  v_add_f32_dpp v50, v43, v50 quad_perm:[3,3,3,3] row_mask:0xf bank_mask:0xf
  v_add_f32_dpp v51, v47, v51 quad_perm:[3,3,3,3] row_mask:0xf bank_mask:0xf
  v_cvt_pk_bf16_f32 v48, 0, v48
  v_cvt_pk_bf16_f32 v49, 0, v49
  v_cvt_pk_bf16_f32 v50, 0, v50
  v_cvt_pk_bf16_f32 v51, 0, v51
  v_max3_f32 v14, v14, v48, v49
  v_max3_f32 v14, v14, v50, v51
  ds_write_b128 v13, v[48:51] offset:640
  v_add_u32 v13, 768, v13
  s_mov_b32 s58, 33
L_kloop:
  s_waitcnt vmcnt(0)
  v_mfma_f32_16x16x32_bf16 v[32:35], v[64:67], v[16:19], 0
  v_mfma_f32_16x16x32_bf16 v[32:35], v[68:71], v[20:23], v[32:35]
  v_mfma_f32_16x16x32_bf16 v[36:39], v[72:75], v[16:19], 0
  v_mfma_f32_16x16x32_bf16 v[36:39], v[76:79], v[20:23], v[36:39]
  v_mfma_f32_16x16x32_bf16 v[40:43], v[80:83], v[16:19], 0
  v_mfma_f32_16x16x32_bf16 v[40:43], v[84:87], v[20:23], v[40:43]
  v_mfma_f32_16x16x32_bf16 v[44:47], v[88:91], v[16:19], 0
  v_mfma_f32_16x16x32_bf16 v[44:47], v[92:95], v[20:23], v[44:47]
  buffer_load_dwordx4 v[64:67], v2, s[32:35], s57 offen offset:0 nt
  buffer_load_dwordx4 v[68:71], v2, s[32:35], s57 offen offset:256 nt
  buffer_load_dwordx4 v[72:75], v2, s[32:35], s57 offen offset:512 nt
  buffer_load_dwordx4 v[76:79], v2, s[32:35], s57 offen offset:768 nt
  buffer_load_dwordx4 v[80:83], v2, s[32:35], s57 offen offset:1024 nt
  buffer_load_dwordx4 v[84:87], v2, s[32:35], s57 offen offset:1280 nt
  buffer_load_dwordx4 v[88:91], v2, s[32:35], s57 offen offset:1536 nt
  buffer_load_dwordx4 v[92:95], v2, s[32:35], s57 offen offset:1792 nt
  s_or_b32 s57, s57, 0x8000
  s_add_u32 s57, s57, 0x6000
  s_andn2_b32 s57, s57, 0x8000
  s_or_b32 s57, s57, s66
  v_mov_b32_dpp v48, v32 quad_perm:[0,0,0,0] row_mask:0xf bank_mask:0xf
  v_mov_b32_dpp v49, v36 quad_perm:[0,0,0,0] row_mask:0xf bank_mask:0xf
  v_mov_b32_dpp v50, v40 quad_perm:[0,0,0,0] row_mask:0xf bank_mask:0xf
  v_mov_b32_dpp v51, v44 quad_perm:[0,0,0,0] row_mask:0xf bank_mask:0xf
  v_add_f32_dpp v48, v33, v48 quad_perm:[1,1,1,1] row_mask:0xf bank_mask:0xf
  v_add_f32_dpp v49, v37, v49 quad_perm:[1,1,1,1] row_mask:0xf bank_mask:0xf
  v_add_f32_dpp v50, v41, v50 quad_perm:[1,1,1,1] row_mask:0xf bank_mask:0xf
  v_add_f32_dpp v51, v45, v51 quad_perm:[1,1,1,1] row_mask:0xf bank_mask:0xf
  v_add_f32_dpp v48, v34, v48 quad_perm:[2,2,2,2] row_mask:0xf bank_mask:0xf
  v_add_f32_dpp v49, v38, v49 quad_perm:[2,2,2,2] row_mask:0xf bank_mask:0xf
  v_add_f32_dpp v50, v42, v50 quad_perm:[2,2,2,2] row_mask:0xf bank_mask:0xf
  v_add_f32_dpp v51, v46, v51 quad_perm:[2,2,2,2] row_mask:0xf bank_mask:0xf
  v_add_f32_dpp v48, v35, v48 quad_perm:[3,3,3,3] row_mask:0xf bank_mask:0xf
  v_add_f32_dpp v49, v39, v49 quad_perm:[3,3,3,3] row_mask:0xf bank_mask:0xf
  v_add_f32_dpp v50, v43, v50 quad_perm:[3,3,3,3] row_mask:0xf bank_mask:0xf
  v_add_f32_dpp v51, v47, v51 quad_perm:[3,3,3,3] row_mask:0xf bank_mask:0xf
  v_cvt_pk_bf16_f32 v48, 0, v48
  v_cvt_pk_bf16_f32 v49, 0, v49
  v_cvt_pk_bf16_f32 v50, 0, v50
  v_cvt_pk_bf16_f32 v51, 0, v51
  v_max3_f32 v14, v14, v48, v49
  v_max3_f32 v14, v14, v50, v51
  ds_write_b128 v13, v[48:51] offset:0
  v_add_u32 v13, 128, v13
  s_sub_u32 s58, s58, 1
  s_cmp_lg_u32 s58, 0
  s_cbranch_scc1 L_kloop
  s_waitcnt vmcnt(0)
  v_mfma_f32_16x16x32_bf16 v[32:35], v[64:67], v[16:19], 0
  v_mfma_f32_16x16x32_bf16 v[32:35], v[68:71], v[20:23], v[32:35]
  v_mfma_f32_16x16x32_bf16 v[36:39], v[72:75], v[16:19], 0
  v_mfma_f32_16x16x32_bf16 v[36:39], v[76:79], v[20:23], v[36:39]
  v_mfma_f32_16x16x32_bf16 v[40:43], v[80:83], v[16:19], 0
  v_mfma_f32_16x16x32_bf16 v[40:43], v[84:87], v[20:23], v[40:43]
  v_mfma_f32_16x16x32_bf16 v[44:47], v[88:91], v[16:19], 0
  v_mfma_f32_16x16x32_bf16 v[44:47], v[92:95], v[20:23], v[44:47]
  s_mov_b32 s57, s56
  buffer_load_dwordx4 v[64:67], v3, s[36:39], s57 offen offset:0 nt
  buffer_load_dwordx4 v[68:71], v3, s[36:39], s57 offen offset:256 nt
  buffer_load_dwordx4 v[72:75], v3, s[36:39], s57 offen offset:512 nt
  buffer_load_dwordx4 v[76:79], v3, s[36:39], s57 offen offset:768 nt
  buffer_load_dwordx4 v[80:83], v3, s[36:39], s57 offen offset:1024 nt
  buffer_load_dwordx4 v[84:87], v3, s[36:39], s57 offen offset:1280 nt
  buffer_load_dwordx4 v[88:91], v3, s[36:39], s57 offen offset:1536 nt
  buffer_load_dwordx4 v[92:95], v3, s[36:39], s57 offen offset:1792 nt
  s_or_b32 s57, s57, 0x8000
  s_add_u32 s57, s57, 0x6000
  s_andn2_b32 s57, s57, 0x8000
  s_or_b32 s57, s57, s66
  v_mov_b32_dpp v48, v32 quad_perm:[0,0,0,0] row_mask:0xf bank_mask:0xf
  v_mov_b32_dpp v49, v36 quad_perm:[0,0,0,0] row_mask:0xf bank_mask:0xf
  v_mov_b32_dpp v50, v40 quad_perm:[0,0,0,0] row_mask:0xf bank_mask:0xf
  v_mov_b32_dpp v51, v44 quad_perm:[0,0,0,0] row_mask:0xf bank_mask:0xf
  v_add_f32_dpp v48, v33, v48 quad_perm:[1,1,1,1] row_mask:0xf bank_mask:0xf
  v_add_f32_dpp v49, v37, v49 quad_perm:[1,1,1,1] row_mask:0xf bank_mask:0xf
  v_add_f32_dpp v50, v41, v50 quad_perm:[1,1,1,1] row_mask:0xf bank_mask:0xf
  v_add_f32_dpp v51, v45, v51 quad_perm:[1,1,1,1] row_mask:0xf bank_mask:0xf
  v_add_f32_dpp v48, v34, v48 quad_perm:[2,2,2,2] row_mask:0xf bank_mask:0xf
  v_add_f32_dpp v49, v38, v49 quad_perm:[2,2,2,2] row_mask:0xf bank_mask:0xf
  v_add_f32_dpp v50, v42, v50 quad_perm:[2,2,2,2] row_mask:0xf bank_mask:0xf
  v_add_f32_dpp v51, v46, v51 quad_perm:[2,2,2,2] row_mask:0xf bank_mask:0xf
  v_add_f32_dpp v48, v35, v48 quad_perm:[3,3,3,3] row_mask:0xf bank_mask:0xf
  v_add_f32_dpp v49, v39, v49 quad_perm:[3,3,3,3] row_mask:0xf bank_mask:0xf
  v_add_f32_dpp v50, v43, v50 quad_perm:[3,3,3,3] row_mask:0xf bank_mask:0xf
  v_add_f32_dpp v51, v47, v51 quad_perm:[3,3,3,3] row_mask:0xf bank_mask:0xf
  v_cvt_pk_bf16_f32 v48, 0, v48
  v_cvt_pk_bf16_f32 v49, 0, v49
  v_cvt_pk_bf16_f32 v50, 0, v50
  v_cvt_pk_bf16_f32 v51, 0, v51
  v_max3_f32 v14, v14, v48, v49
  v_max3_f32 v14, v14, v50, v51
  ds_write_b128 v13, v[48:51] offset:0
  v_subrev_u32 v13, 4992, v13
  v_mov_b32 v10, v14
  s_nop 1
  v_permlane32_swap_b32 v10, v14
  s_nop 1
  v_max_f32 v14, v10, v14
  v_mov_b32 v10, v14
  s_nop 1
  v_permlane16_swap_b32 v10, v14
  s_nop 1
  v_max_f32 v14, v10, v14
  v_mul_f32 v11, s59, v14
  s_mov_b32 s58, 38
L_vloop:
  ds_read_b128 v[48:51], v13 offset:0
  s_waitcnt lgkmcnt(0)
  v_fma_f32 v48, v48, s59, -v11
  v_fma_f32 v49, v49, s59, -v11
  v_fma_f32 v50, v50, s59, -v11
  v_fma_f32 v51, v51, s59, -v11
  v_exp_f32 v48, v48
  v_exp_f32 v49, v49
  v_exp_f32 v50, v50
  v_exp_f32 v51, v51
  s_nop 0
  v_add_f32 v56, v48, v49
  v_add_f32 v57, v50, v51
  v_cvt_pk_bf16_f32 v48, v48, v48
  v_cvt_pk_bf16_f32 v49, v49, v49
  v_cvt_pk_bf16_f32 v50, v50, v50
  v_cvt_pk_bf16_f32 v51, v51, v51
  v_add_f32 v56, v56, v57
  v_add_f32 v15, v15, v56
  v_and_b32 v32, v48, v4
  v_and_b32 v33, v48, v5
  v_and_b32 v34, v48, v6
  v_and_b32 v35, v48, v7
  v_and_b32 v36, v49, v4
  v_and_b32 v37, v49, v5
  v_and_b32 v38, v49, v6
  v_and_b32 v39, v49, v7
  v_and_b32 v40, v50, v4
  v_and_b32 v41, v50, v5
  v_and_b32 v42, v50, v6
  v_and_b32 v43, v50, v7
  v_and_b32 v44, v51, v4
  v_and_b32 v45, v51, v5
  v_and_b32 v46, v51, v6
  v_and_b32 v47, v51, v7
  s_waitcnt vmcnt(0)
  v_mfma_f32_16x16x32_bf16 v[24:27], v[32:35], v[64:67], v[24:27]
  v_mfma_f32_16x16x32_bf16 v[28:31], v[32:35], v[68:71], v[28:31]
  v_mfma_f32_16x16x32_bf16 v[24:27], v[36:39], v[72:75], v[24:27]
  v_mfma_f32_16x16x32_bf16 v[28:31], v[36:39], v[76:79], v[28:31]
  v_mfma_f32_16x16x32_bf16 v[24:27], v[40:43], v[80:83], v[24:27]
  v_mfma_f32_16x16x32_bf16 v[28:31], v[40:43], v[84:87], v[28:31]
  v_mfma_f32_16x16x32_bf16 v[24:27], v[44:47], v[88:91], v[24:27]
  v_mfma_f32_16x16x32_bf16 v[28:31], v[44:47], v[92:95], v[28:31]
  buffer_load_dwordx4 v[64:67], v3, s[36:39], s57 offen offset:0 nt
  buffer_load_dwordx4 v[68:71], v3, s[36:39], s57 offen offset:256 nt
  buffer_load_dwordx4 v[72:75], v3, s[36:39], s57 offen offset:512 nt
  buffer_load_dwordx4 v[76:79], v3, s[36:39], s57 offen offset:768 nt
  buffer_load_dwordx4 v[80:83], v3, s[36:39], s57 offen offset:1024 nt
  buffer_load_dwordx4 v[84:87], v3, s[36:39], s57 offen offset:1280 nt
  buffer_load_dwordx4 v[88:91], v3, s[36:39], s57 offen offset:1536 nt
  buffer_load_dwordx4 v[92:95], v3, s[36:39], s57 offen offset:1792 nt
  s_or_b32 s57, s57, 0x8000
  s_add_u32 s57, s57, 0x6000
  s_andn2_b32 s57, s57, 0x8000
  s_or_b32 s57, s57, s66
  v_add_u32 v13, 128, v13
  s_sub_u32 s58, s58, 1
  s_cmp_lg_u32 s58, 0
  s_cbranch_scc1 L_vloop
  ds_read_b128 v[48:51], v13 offset:0
  s_waitcnt lgkmcnt(0)
  v_fma_f32 v48, v48, s59, -v11
  v_fma_f32 v49, v49, s59, -v11
  v_fma_f32 v50, v50, s59, -v11
  v_fma_f32 v51, v51, s59, -v11
  v_exp_f32 v48, v48
  v_exp_f32 v49, v49
  v_exp_f32 v50, v50
  v_exp_f32 v51, v51
  s_nop 0
  v_add_f32 v56, v48, v49
  v_add_f32 v57, v50, v51
  v_cvt_pk_bf16_f32 v48, v48, v48
  v_cvt_pk_bf16_f32 v49, v49, v49
  v_cvt_pk_bf16_f32 v50, v50, v50
  v_cvt_pk_bf16_f32 v51, v51, v51
  v_add_f32 v56, v56, v57
  v_add_f32 v15, v15, v56
  v_and_b32 v32, v48, v4
  v_and_b32 v33, v48, v5
  v_and_b32 v34, v48, v6
  v_and_b32 v35, v48, v7
  v_and_b32 v36, v49, v4
  v_and_b32 v37, v49, v5
  v_and_b32 v38, v49, v6
  v_and_b32 v39, v49, v7
  v_and_b32 v40, v50, v4
  v_and_b32 v41, v50, v5
  v_and_b32 v42, v50, v6
  v_and_b32 v43, v50, v7
  v_and_b32 v44, v51, v4
  v_and_b32 v45, v51, v5
  v_and_b32 v46, v51, v6
  v_and_b32 v47, v51, v7
  s_waitcnt vmcnt(0)
  v_mfma_f32_16x16x32_bf16 v[24:27], v[32:35], v[64:67], v[24:27]
  v_mfma_f32_16x16x32_bf16 v[28:31], v[32:35], v[68:71], v[28:31]
  v_mfma_f32_16x16x32_bf16 v[24:27], v[36:39], v[72:75], v[24:27]
  v_mfma_f32_16x16x32_bf16 v[28:31], v[36:39], v[76:79], v[28:31]
  v_mfma_f32_16x16x32_bf16 v[24:27], v[40:43], v[80:83], v[24:27]
  v_mfma_f32_16x16x32_bf16 v[28:31], v[40:43], v[84:87], v[28:31]
  v_mfma_f32_16x16x32_bf16 v[24:27], v[44:47], v[88:91], v[24:27]
  v_mfma_f32_16x16x32_bf16 v[28:31], v[44:47], v[92:95], v[28:31]
  buffer_load_dwordx4 v[64:67], v3, s[36:39], s57 offen offset:0 nt
  buffer_load_dwordx4 v[68:71], v3, s[36:39], s57 offen offset:256 nt
  buffer_load_dwordx4 v[72:75], v3, s[36:39], s57 offen offset:512 nt
  buffer_load_dwordx4 v[76:79], v3, s[36:39], s57 offen offset:768 nt
  buffer_load_dwordx4 v[80:83], v3, s[36:39], s57 offen offset:1024 nt
  buffer_load_dwordx4 v[84:87], v3, s[36:39], s57 offen offset:1280 nt
  buffer_load_dwordx4 v[88:91], v3, s[36:39], s57 offen offset:1536 nt
  buffer_load_dwordx4 v[92:95], v3, s[36:39], s57 offen offset:1792 nt
  s_or_b32 s57, s57, 0x8000
  s_add_u32 s57, s57, 0x6000
  s_andn2_b32 s57, s57, 0x8000
  s_or_b32 s57, s57, s66
  v_mov_b32 v58, 0
  v_mov_b32 v59, 1
  s_mov_b64 exec, 1
  ds_add_rtn_u32 v59, v58, v59 offset:23360
  s_mov_b64 exec, -1
  v_lshrrev_b32 v61, 1, v9
  v_lshlrev_b32 v61, 10, v61
  v_lshl_add_u32 v61, v8, 5, v61
  v_and_b32 v62, 1, v9
  v_lshl_add_u32 v61, v62, 4, v61
  s_lshl_b32 s58, s3, 11
  v_add_u32 v61, s58, v61
  s_lshl_b32 s58, s3, 4
  v_and_b32 v62, 8, v1
  v_add_u32 v62, s58, v62
  s_and_b32 s69, s31, 7
  s_mul_i32 s69, s69, 14
  s_lshr_b32 s67, s31, 3
  s_add_u32 s69, s69, s67
  s_mul_i32 s69, s69, 14336
  s_cmp_lt_u32 s31, 112
  s_cselect_b32 s46, 1605632, 0
  s_mov_b32 s44, s18
  s_mov_b32 s45, s19
  s_mov_b32 s47, 0x00020000
  s_mov_b32 s48, s12
  s_mov_b32 s49, s13
  s_mov_b32 s50, 3670016
  s_mov_b32 s51, 0x00020000
  s_lshl_b32 s64, s3, 8
  s_add_u32 s69, s69, s64
  s_mul_i32 s67, s31, 28672
  s_add_u32 s67, s67, s64
  s_add_u32 s68, s67, 3584
  s_lshl_b32 s64, s64, 1
  s_mul_i32 s52, s2, 1792
  s_add_u32 s64, s64, s52
  s_add_u32 s64, s64, 2097152
  s_cmp_eq_u32 s3, 3
  s_cselect_b32 s52, 0x00ff00ff, -1
  s_mov_b32 s53, 0
  v_mul_u32_u24 v54, 3584, v9
  v_lshl_add_u32 v54, v8, 4, v54
  v_mul_u32_u24 v55, 7168, v9
  v_lshl_add_u32 v55, v8, 4, v55
  v_lshlrev_b32 v53, 5, v8
  v_lshl_add_u32 v53, v9, 4, v53
  v_lshlrev_b32 v52, 4, v9
  ds_read_b128 v[48:51], v13 offset:128
  s_waitcnt lgkmcnt(0)
  v_fma_f32 v48, v48, s59, -v11
  v_fma_f32 v49, v49, s59, -v11
  v_fma_f32 v50, v50, s59, -v11
  v_fma_f32 v51, v51, s59, -v11
  v_exp_f32 v48, v48
  v_exp_f32 v49, v49
  v_exp_f32 v50, v50
  v_exp_f32 v51, v51
  s_nop 0
  v_add_f32 v56, v48, v49
  v_add_f32 v57, v50, v51
  v_cvt_pk_bf16_f32 v48, v48, v48
  v_cvt_pk_bf16_f32 v49, v49, v49
  v_cvt_pk_bf16_f32 v50, v50, v50
  v_cvt_pk_bf16_f32 v51, v51, v51
  v_add_f32 v56, v56, v57
  v_add_f32 v15, v15, v56
  v_and_b32 v32, v48, v4
  v_and_b32 v33, v48, v5
  v_and_b32 v34, v48, v6
  v_and_b32 v35, v48, v7
  v_and_b32 v36, v49, v4
  v_and_b32 v37, v49, v5
  v_and_b32 v38, v49, v6
  v_and_b32 v39, v49, v7
  v_and_b32 v40, v50, v4
  v_and_b32 v41, v50, v5
  v_and_b32 v42, v50, v6
  v_and_b32 v43, v50, v7
  v_and_b32 v44, v51, v4
  v_and_b32 v45, v51, v5
  v_and_b32 v46, v51, v6
  v_and_b32 v47, v51, v7
  s_waitcnt lgkmcnt(0)
  v_readfirstlane_b32 s76, v59
  s_mul_i32 s77, s76, 21846
  s_lshr_b32 s77, s77, 16
  s_mul_i32 s79, s77, 3
  s_sub_u32 s76, s76, s79
  s_lshl_b32 s77, s77, 2
  v_mov_b32 v58, s77
  s_waitcnt vmcnt(0)
  ds_read_b32 v60, v58 offset:23424
  v_mfma_f32_16x16x32_bf16 v[24:27], v[32:35], v[64:67], v[24:27]
  v_mfma_f32_16x16x32_bf16 v[28:31], v[32:35], v[68:71], v[28:31]
  v_mfma_f32_16x16x32_bf16 v[24:27], v[36:39], v[72:75], v[24:27]
  v_mfma_f32_16x16x32_bf16 v[28:31], v[36:39], v[76:79], v[28:31]
  v_mfma_f32_16x16x32_bf16 v[24:27], v[40:43], v[80:83], v[24:27]
  v_mfma_f32_16x16x32_bf16 v[28:31], v[40:43], v[84:87], v[28:31]
  v_mfma_f32_16x16x32_bf16 v[24:27], v[44:47], v[88:91], v[24:27]
  v_mfma_f32_16x16x32_bf16 v[28:31], v[44:47], v[92:95], v[28:31]
L_next:
  s_mov_b32 s79, 6400000
L_win:
  s_waitcnt lgkmcnt(0)
  v_readfirstlane_b32 s77, v60
  s_cmp_lg_u32 s77, -1
  s_cbranch_scc1 L_win_ok
  s_sleep 1
  ds_read_b32 v60, v58 offset:23424
  s_sub_u32 s79, s79, 1
  s_cmp_lg_u32 s79, 0
  s_cbranch_scc1 L_win
L_win_ok:
  s_cmp_ge_u32 s77, 43
  s_cbranch_scc1 L_dyn_done
  s_mul_i32 s77, s77, 3
  s_add_u32 s77, s77, s76
  s_cmp_ge_u32 s77, 128
  s_cbranch_scc1 L_dyn_done
  s_lshl_b32 s78, s28, 24
  s_and_b32 s79, s77, 7
  s_lshl_b32 s79, s79, 13
  s_or_b32 s78, s78, s79
  s_bfe_u32 s79, s77, 0x30003
  s_lshl_b32 s79, s79, 21
  s_or_b32 s78, s78, s79
  s_lshr_b32 s79, s77, 6
  s_add_u32 s79, s79, 30
  s_lshl_b32 s79, s79, 16
  s_or_b32 s78, s78, s79
  buffer_load_dwordx4 v[128:131], v2, s[32:35], s78 offen offset:0 nt
  buffer_load_dwordx4 v[132:135], v2, s[32:35], s78 offen offset:256 nt
  buffer_load_dwordx4 v[136:139], v2, s[32:35], s78 offen offset:512 nt
  buffer_load_dwordx4 v[140:143], v2, s[32:35], s78 offen offset:768 nt
  buffer_load_dwordx4 v[144:147], v2, s[32:35], s78 offen offset:1024 nt
  buffer_load_dwordx4 v[148:151], v2, s[32:35], s78 offen offset:1280 nt
  buffer_load_dwordx4 v[152:155], v2, s[32:35], s78 offen offset:1536 nt
  buffer_load_dwordx4 v[156:159], v2, s[32:35], s78 offen offset:1792 nt
  buffer_load_dwordx4 v[160:163], v3, s[36:39], s78 offen offset:0 nt
  buffer_load_dwordx4 v[164:167], v3, s[36:39], s78 offen offset:256 nt
  buffer_load_dwordx4 v[168:171], v3, s[36:39], s78 offen offset:512 nt
  buffer_load_dwordx4 v[172:175], v3, s[36:39], s78 offen offset:768 nt
  buffer_load_dwordx4 v[176:179], v3, s[36:39], s78 offen offset:1024 nt
  buffer_load_dwordx4 v[180:183], v3, s[36:39], s78 offen offset:1280 nt
  buffer_load_dwordx4 v[184:187], v3, s[36:39], s78 offen offset:1536 nt
  buffer_load_dwordx4 v[188:191], v3, s[36:39], s78 offen offset:1792 nt
  s_waitcnt vmcnt(8)
  v_mov_b32 v58, 0
  v_mov_b32 v59, 1
  s_mov_b64 exec, 1
  ds_add_rtn_u32 v59, v58, v59 offset:23360
  s_mov_b64 exec, -1
  v_mfma_f32_16x16x32_bf16 v[32:35], v[128:131], v[16:19], 0
  v_mfma_f32_16x16x32_bf16 v[32:35], v[132:135], v[20:23], v[32:35]
  v_mfma_f32_16x16x32_bf16 v[36:39], v[136:139], v[16:19], 0
  v_mfma_f32_16x16x32_bf16 v[36:39], v[140:143], v[20:23], v[36:39]
  v_mfma_f32_16x16x32_bf16 v[40:43], v[144:147], v[16:19], 0
  v_mfma_f32_16x16x32_bf16 v[40:43], v[148:151], v[20:23], v[40:43]
  v_mfma_f32_16x16x32_bf16 v[44:47], v[152:155], v[16:19], 0
  v_mfma_f32_16x16x32_bf16 v[44:47], v[156:159], v[20:23], v[44:47]
  s_nop 4
  v_mov_b32_dpp v48, v32 quad_perm:[0,0,0,0] row_mask:0xf bank_mask:0xf
  v_mov_b32_dpp v49, v36 quad_perm:[0,0,0,0] row_mask:0xf bank_mask:0xf
  v_mov_b32_dpp v50, v40 quad_perm:[0,0,0,0] row_mask:0xf bank_mask:0xf
  v_mov_b32_dpp v51, v44 quad_perm:[0,0,0,0] row_mask:0xf bank_mask:0xf
  v_add_f32_dpp v48, v33, v48 quad_perm:[1,1,1,1] row_mask:0xf bank_mask:0xf
  v_add_f32_dpp v49, v37, v49 quad_perm:[1,1,1,1] row_mask:0xf bank_mask:0xf
  v_add_f32_dpp v50, v41, v50 quad_perm:[1,1,1,1] row_mask:0xf bank_mask:0xf
  v_add_f32_dpp v51, v45, v51 quad_perm:[1,1,1,1] row_mask:0xf bank_mask:0xf
  v_add_f32_dpp v48, v34, v48 quad_perm:[2,2,2,2] row_mask:0xf bank_mask:0xf
  v_add_f32_dpp v49, v38, v49 quad_perm:[2,2,2,2] row_mask:0xf bank_mask:0xf
  v_add_f32_dpp v50, v42, v50 quad_perm:[2,2,2,2] row_mask:0xf bank_mask:0xf
  v_add_f32_dpp v51, v46, v51 quad_perm:[2,2,2,2] row_mask:0xf bank_mask:0xf
  v_add_f32_dpp v48, v35, v48 quad_perm:[3,3,3,3] row_mask:0xf bank_mask:0xf
  v_add_f32_dpp v49, v39, v49 quad_perm:[3,3,3,3] row_mask:0xf bank_mask:0xf
  v_add_f32_dpp v50, v43, v50 quad_perm:[3,3,3,3] row_mask:0xf bank_mask:0xf
  v_add_f32_dpp v51, v47, v51 quad_perm:[3,3,3,3] row_mask:0xf bank_mask:0xf
  v_cvt_pk_bf16_f32 v48, 0, v48
  v_cvt_pk_bf16_f32 v49, 0, v49
  v_cvt_pk_bf16_f32 v50, 0, v50
  v_cvt_pk_bf16_f32 v51, 0, v51
  v_max3_f32 v10, v48, v49, v50
  v_max_f32 v10, v10, v51
  v_cmp_gt_f32 vcc, v10, v14
  s_cbranch_vccnz L_rare
L_back:
  v_fma_f32 v48, v48, s59, -v11
  v_fma_f32 v49, v49, s59, -v11
  v_fma_f32 v50, v50, s59, -v11
  v_fma_f32 v51, v51, s59, -v11
  v_exp_f32 v48, v48
  v_exp_f32 v49, v49
  v_exp_f32 v50, v50
  v_exp_f32 v51, v51
  s_nop 0
  v_add_f32 v56, v48, v49
  v_add_f32 v57, v50, v51
  v_cvt_pk_bf16_f32 v48, v48, v48
  v_cvt_pk_bf16_f32 v49, v49, v49
  v_cvt_pk_bf16_f32 v50, v50, v50
  v_cvt_pk_bf16_f32 v51, v51, v51
  v_add_f32 v56, v56, v57
  v_add_f32 v15, v15, v56
  v_and_b32 v32, v48, v4
  v_and_b32 v33, v48, v5
  v_and_b32 v34, v48, v6
  v_and_b32 v35, v48, v7
  v_and_b32 v36, v49, v4
  v_and_b32 v37, v49, v5
  v_and_b32 v38, v49, v6
  v_and_b32 v39, v49, v7
  v_and_b32 v40, v50, v4
  v_and_b32 v41, v50, v5
  v_and_b32 v42, v50, v6
  v_and_b32 v43, v50, v7
  v_and_b32 v44, v51, v4
  v_and_b32 v45, v51, v5
  v_and_b32 v46, v51, v6
  v_and_b32 v47, v51, v7
  s_waitcnt lgkmcnt(0)
  v_readfirstlane_b32 s76, v59
  s_mul_i32 s77, s76, 21846
  s_lshr_b32 s77, s77, 16
  s_mul_i32 s79, s77, 3
  s_sub_u32 s76, s76, s79
  s_lshl_b32 s77, s77, 2
  v_mov_b32 v58, s77
  s_waitcnt vmcnt(0)
  ds_read_b32 v60, v58 offset:23424
  v_mfma_f32_16x16x32_bf16 v[24:27], v[32:35], v[160:163], v[24:27]
  v_mfma_f32_16x16x32_bf16 v[28:31], v[32:35], v[164:167], v[28:31]
  v_mfma_f32_16x16x32_bf16 v[24:27], v[36:39], v[168:171], v[24:27]
  v_mfma_f32_16x16x32_bf16 v[28:31], v[36:39], v[172:175], v[28:31]
  v_mfma_f32_16x16x32_bf16 v[24:27], v[40:43], v[176:179], v[24:27]
  v_mfma_f32_16x16x32_bf16 v[28:31], v[40:43], v[180:183], v[28:31]
  v_mfma_f32_16x16x32_bf16 v[24:27], v[44:47], v[184:187], v[24:27]
  v_mfma_f32_16x16x32_bf16 v[28:31], v[44:47], v[188:191], v[28:31]
  s_branch L_next
L_rare:
  v_max_f32 v10, v10, v14
  v_mov_b32 v56, v10
  s_nop 1
  v_permlane32_swap_b32 v56, v10
  s_nop 1
  v_max_f32 v10, v10, v56
  v_mov_b32 v56, v10
  s_nop 1
  v_permlane16_swap_b32 v56, v10
  s_nop 1
  v_max_f32 v10, v10, v56
  v_sub_f32 v56, v14, v10
  v_mul_f32 v56, s59, v56
  v_exp_f32 v56, v56
  v_mov_b32 v14, v10
  v_mul_f32 v11, s59, v10
  v_mul_f32 v15, v15, v56
  v_readlane_b32 s60, v56, 0
  v_readlane_b32 s61, v56, 8
  s_mov_b32 s62, 0
  s_mov_b32 s63, -1
  v_mov_b32 v57, s60
  s_mov_b64 exec, s[62:63]
  v_mov_b32 v57, s61
  s_mov_b64 exec, -1
  v_mul_f32 v24, v57, v24
  v_mul_f32 v25, v57, v25
  v_mul_f32 v26, v57, v26
  v_mul_f32 v27, v57, v27
  v_mul_f32 v28, v57, v28
  v_mul_f32 v29, v57, v29
  v_mul_f32 v30, v57, v30
  v_mul_f32 v31, v57, v31
  s_branch L_back
L_dyn_done:
  v_mov_b32 v10, v15
  s_nop 1
  v_permlane32_swap_b32 v10, v15
  s_nop 0
  v_add_f32 v15, v10, v15
  v_mov_b32 v10, v15
  ds_write_b128 v61, v[24:27] offset:16384
  ds_write_b128 v61, v[28:31] offset:16896
  v_permlane16_swap_b32 v10, v15
  s_nop 0
  v_add_f32 v15, v10, v15
  s_mov_b64 exec, 0x101
  ds_write_b64 v62, v[14:15] offset:22528
  s_mov_b64 exec, -1
  s_waitcnt lgkmcnt(0)
  s_barrier
  v_mov_b32 v10, 0
  ds_read_b128 v[80:83], v52 offset:22592
  ds_read_b64 v[2:3], v10 offset:22656
  v_lshlrev_b32 v52, 1, v52
  s_waitcnt lgkmcnt(0)
  v_and_b32 v24, v80, v4
  v_and_b32 v25, v80, v5
  v_and_b32 v26, v80, v6
  v_and_b32 v27, v80, v7
  v_and_b32 v28, v81, v4
  v_and_b32 v29, v81, v5
  v_and_b32 v30, v81, v6
  v_and_b32 v31, v81, v7
  v_and_b32 v32, v82, v4
  v_and_b32 v33, v82, v5
  v_and_b32 v34, v82, v6
  v_and_b32 v35, v82, v7
  v_and_b32 v36, v83, v4
  v_and_b32 v37, v83, v5
  v_and_b32 v38, v83, v6
  v_and_b32 v39, v83, v7
  s_barrier
  buffer_load_dwordx4 v[160:163], v54, s[44:47], s69 offen offset:0
  buffer_load_dwordx4 v[164:167], v54, s[44:47], s69 offen offset:896
  buffer_load_dwordx4 v[168:171], v54, s[44:47], s69 offen offset:1792
  buffer_load_dwordx4 v[172:175], v54, s[44:47], s69 offen offset:2688
  buffer_load_dwordx4 v[128:131], v55, s[48:51], s67 offen offset:0
  buffer_load_dwordx4 v[132:135], v55, s[48:51], s67 offen offset:896
  buffer_load_dwordx4 v[136:139], v55, s[48:51], s67 offen offset:1792
  buffer_load_dwordx4 v[140:143], v55, s[48:51], s67 offen offset:2688
  buffer_load_dwordx4 v[144:147], v55, s[48:51], s68 offen offset:0
  buffer_load_dwordx4 v[148:151], v55, s[48:51], s68 offen offset:896
  buffer_load_dwordx4 v[152:155], v55, s[48:51], s68 offen offset:1792
  buffer_load_dwordx4 v[156:159], v55, s[48:51], s68 offen offset:2688
L_out:
  s_barrier
  ds_read_b128 v[72:75], v52 offset:22720
  ds_read_b128 v[76:79], v52 offset:22736
  s_waitcnt vmcnt(0)
  v_mfma_f32_16x16x32_bf16 v[20:23], v[24:27], v[160:163], 0
  v_mfma_f32_16x16x32_bf16 v[20:23], v[28:31], v[164:167], v[20:23]
  v_mfma_f32_16x16x32_bf16 v[20:23], v[32:35], v[168:171], v[20:23]
  v_mfma_f32_16x16x32_bf16 v[20:23], v[36:39], v[172:175], v[20:23]
  s_waitcnt lgkmcnt(0)
  v_and_b32 v88, v72, v4
  v_and_b32 v89, v72, v5
  v_and_b32 v90, v72, v6
  v_and_b32 v91, v72, v7
  v_and_b32 v92, v73, v4
  v_and_b32 v93, v73, v5
  v_and_b32 v94, v73, v6
  v_and_b32 v95, v73, v7
  v_mfma_f32_16x16x32_bf16 v[16:19], v[88:91], v[128:131], 0
  v_and_b32 v96, v74, v4
  v_and_b32 v97, v74, v5
  v_and_b32 v98, v74, v6
  v_and_b32 v99, v74, v7
  v_mfma_f32_16x16x32_bf16 v[16:19], v[92:95], v[132:135], v[16:19]
  v_and_b32 v100, v75, v4
  v_and_b32 v101, v75, v5
  v_and_b32 v102, v75, v6
  v_and_b32 v103, v75, v7
  v_mfma_f32_16x16x32_bf16 v[16:19], v[96:99], v[136:139], v[16:19]
  v_and_b32 v104, v76, v4
  v_and_b32 v105, v76, v5
  v_and_b32 v106, v76, v6
  v_and_b32 v107, v76, v7
  v_mfma_f32_16x16x32_bf16 v[16:19], v[100:103], v[140:143], v[16:19]
  v_and_b32 v108, v77, v4
  v_and_b32 v109, v77, v5
  v_and_b32 v110, v77, v6
  v_and_b32 v111, v77, v7
  v_mfma_f32_16x16x32_bf16 v[16:19], v[104:107], v[144:147], v[16:19]
  v_and_b32 v112, v78, v4
  v_and_b32 v113, v78, v5
  v_and_b32 v114, v78, v6
  v_and_b32 v115, v78, v7
  v_mfma_f32_16x16x32_bf16 v[16:19], v[108:111], v[148:151], v[16:19]
  v_and_b32 v116, v79, v4
  v_and_b32 v117, v79, v5
  v_and_b32 v118, v79, v6
  v_and_b32 v119, v79, v7
  v_mfma_f32_16x16x32_bf16 v[16:19], v[112:115], v[152:155], v[16:19]
  s_nop 0
  v_mfma_f32_16x16x32_bf16 v[16:19], v[116:119], v[156:159], v[16:19]
  s_mov_b64 exec, s[52:53]
  v_mul_f32 v20, v3, v20
  v_mul_f32 v21, v3, v21
  v_mul_f32 v22, v3, v22
  v_mul_f32 v23, v3, v23
  s_nop 2
  v_fmac_f32 v20, v2, v16
  v_fmac_f32 v21, v2, v17
  v_fmac_f32 v22, v2, v18
  v_fmac_f32 v23, v2, v19
  buffer_store_dwordx4 v[20:23], v53, s[40:43], s64 offen sc1
  s_mov_b64 exec, -1
  s_cmp_lg_u32 s3, 0
  s_cbranch_scc1 L_fin
  s_cmp_ge_u32 s31, 28
  s_cbranch_scc1 L_fin
  s_mov_b32 s44, s22
  s_mov_b32 s45, s23
  s_mov_b32 s46, 1792
  s_mov_b32 s47, 0x00020000
  v_lshrrev_b32 v10, 2, v1
  v_mul_u32_u24 v10, 1792, v10
  v_and_b32 v11, 3, v1
  v_lshl_add_u32 v10, v11, 4, v10
  s_mul_i32 s58, s30, 229376
  s_lshl_b32 s61, s31, 6
  s_add_u32 s58, s58, s61
  s_add_u32 s58, s58, 2097152
  s_add_u32 s48, s58, 0
  s_add_u32 s49, s58, 28672
  s_add_u32 s50, s58, 57344
  s_add_u32 s51, s58, 86016
  s_add_u32 s52, s58, 114688
  s_add_u32 s53, s58, 143360
  s_add_u32 s54, s58, 172032
  s_add_u32 s55, s58, 200704
  v_lshrrev_b32 v14, 5, v1
  v_lshlrev_b32 v14, 2, v14
  v_lshl_add_u32 v14, v11, 3, v14
  s_mul_i32 s58, s30, 896
  s_lshl_b32 s61, s31, 5
  s_add_u32 s58, s58, s61
  s_mov_b32 s60, 200000
  s_mov_b64 s[64:65], -1
  s_mov_b64 s[66:67], -1
  s_mov_b64 s[68:69], -1
  s_mov_b64 s[70:71], -1
  s_mov_b64 s[72:73], -1
  s_mov_b64 s[74:75], -1
  s_mov_b64 s[76:77], -1
  s_mov_b64 s[78:79], -1
L_poll2:
  s_mov_b64 exec, s[64:65]
  s_cbranch_execz L_p2s0
  buffer_load_dwordx4 v[64:67], v10, s[40:43], s48 offen sc1
L_p2s0:
  s_mov_b64 exec, s[66:67]
  s_cbranch_execz L_p2s1
  buffer_load_dwordx4 v[68:71], v10, s[40:43], s49 offen sc1
L_p2s1:
  s_mov_b64 exec, s[68:69]
  s_cbranch_execz L_p2s2
  buffer_load_dwordx4 v[72:75], v10, s[40:43], s50 offen sc1
L_p2s2:
  s_mov_b64 exec, s[70:71]
  s_cbranch_execz L_p2s3
  buffer_load_dwordx4 v[76:79], v10, s[40:43], s51 offen sc1
L_p2s3:
  s_mov_b64 exec, s[72:73]
  s_cbranch_execz L_p2s4
  buffer_load_dwordx4 v[80:83], v10, s[40:43], s52 offen sc1
L_p2s4:
  s_mov_b64 exec, s[74:75]
  s_cbranch_execz L_p2s5
  buffer_load_dwordx4 v[84:87], v10, s[40:43], s53 offen sc1
L_p2s5:
  s_mov_b64 exec, s[76:77]
  s_cbranch_execz L_p2s6
  buffer_load_dwordx4 v[88:91], v10, s[40:43], s54 offen sc1
L_p2s6:
  s_mov_b64 exec, s[78:79]
  s_cbranch_execz L_p2s7
  buffer_load_dwordx4 v[92:95], v10, s[40:43], s55 offen sc1
L_p2s7:
  s_mov_b64 exec, -1
  s_waitcnt vmcnt(0)
  v_max3_u32 v12, v64, v65, v66
  v_max_u32 v12, v12, v67
  v_cmp_eq_u32 s[64:65], -1, v12
  v_max3_u32 v13, v68, v69, v70
  v_max_u32 v13, v13, v71
  v_cmp_eq_u32 s[66:67], -1, v13
  v_max3_u32 v12, v72, v73, v74
  v_max_u32 v12, v12, v75
  v_cmp_eq_u32 s[68:69], -1, v12
  v_max3_u32 v13, v76, v77, v78
  v_max_u32 v13, v13, v79
  v_cmp_eq_u32 s[70:71], -1, v13
  v_max3_u32 v12, v80, v81, v82
  v_max_u32 v12, v12, v83
  v_cmp_eq_u32 s[72:73], -1, v12
  v_max3_u32 v13, v84, v85, v86
  v_max_u32 v13, v13, v87
  v_cmp_eq_u32 s[74:75], -1, v13
  v_max3_u32 v12, v88, v89, v90
  v_max_u32 v12, v12, v91
  v_cmp_eq_u32 s[76:77], -1, v12
  v_max3_u32 v13, v92, v93, v94
  v_max_u32 v13, v13, v95
  v_cmp_eq_u32 s[78:79], -1, v13
  s_or_b64 s[62:63], s[64:65], s[66:67]
  s_or_b64 s[62:63], s[62:63], s[68:69]
  s_or_b64 s[62:63], s[62:63], s[70:71]
  s_or_b64 s[62:63], s[62:63], s[72:73]
  s_or_b64 s[62:63], s[62:63], s[74:75]
  s_or_b64 s[62:63], s[62:63], s[76:77]
  s_or_b64 s[62:63], s[62:63], s[78:79]
  s_cbranch_scc0 L_poll2_done
  s_sleep 2
  s_sub_u32 s60, s60, 1
  s_cmp_lg_u32 s60, 0
  s_cbranch_scc1 L_poll2
L_poll2_done:
  v_add_f32 v64, v64, v80
  v_add_f32 v65, v65, v81
  v_add_f32 v66, v66, v82
  v_add_f32 v67, v67, v83
  v_add_f32 v68, v68, v84
  v_add_f32 v69, v69, v85
  v_add_f32 v70, v70, v86
  v_add_f32 v71, v71, v87
  v_add_f32 v72, v72, v88
  v_add_f32 v73, v73, v89
  v_add_f32 v74, v74, v90
  v_add_f32 v75, v75, v91
  v_add_f32 v76, v76, v92
  v_add_f32 v77, v77, v93
  v_add_f32 v78, v78, v94
  v_add_f32 v79, v79, v95
  v_add_f32 v64, v64, v72
  v_add_f32 v65, v65, v73
  v_add_f32 v66, v66, v74
  v_add_f32 v67, v67, v75
  v_add_f32 v68, v68, v76
  v_add_f32 v69, v69, v77
  v_add_f32 v70, v70, v78
  v_add_f32 v71, v71, v79
  v_add_f32 v64, v64, v68
  v_add_f32 v65, v65, v69
  v_add_f32 v66, v66, v70
  v_add_f32 v67, v67, v71
  s_nop 1
  v_permlane32_swap_b32 v64, v66
  v_permlane32_swap_b32 v65, v67
  s_nop 1
  v_add_f32 v64, v64, v66
  v_add_f32 v65, v65, v67
  v_mov_b32 v66, v64
  v_mov_b32 v67, v65
  s_nop 1
  v_permlane16_swap_b32 v66, v64
  v_permlane16_swap_b32 v67, v65
  s_nop 1
  v_add_f32 v64, v64, v66
  v_add_f32 v65, v65, v67
  s_nop 1
  v_add_f32_dpp v64, v64, v64 row_ror:8 row_mask:0xf bank_mask:0xf
  v_add_f32_dpp v65, v65, v65 row_ror:8 row_mask:0xf bank_mask:0xf
  s_nop 1
  v_add_f32_dpp v64, v64, v64 row_ror:4 row_mask:0xf bank_mask:0xf
  v_add_f32_dpp v65, v65, v65 row_ror:4 row_mask:0xf bank_mask:0xf
  s_mov_b32 s60, 15
  s_mov_b32 s61, 15
  v_cvt_pk_bf16_f32 v64, v64, v65
  s_mov_b64 exec, s[60:61]
  buffer_store_dword v64, v14, s[44:47], s58 offen sc1
  s_mov_b64 exec, -1
L_fin:
  s_endpgm
L_service:
  v_mov_b32 v48, -1
  v_mov_b32 v49, -1
  v_mov_b32 v50, -1
  v_mov_b32 v51, -1
  v_lshlrev_b32 v14, 4, v1
  v_mov_b32 v15, 0
  ds_write_b32 v15, v15 offset:23360
  ds_write_b128 v14, v[48:51] offset:23424
  v_mov_b32 v16, 0
  v_mov_b32 v17, 0
  v_mov_b32 v18, 0
  v_mov_b32 v19, 0
  v_mov_b32 v20, 0
  v_mov_b32 v21, 0
  v_mov_b32 v22, 0
  v_mov_b32 v23, 0
  s_lshl_b32 s58, s3, 7
  v_add_u32 v13, s58, v12
  s_waitcnt vmcnt(6)
  v_perm_b32 v52, v228, v224, s60
  v_perm_b32 v56, v228, v224, s61
  v_perm_b32 v53, v229, v225, s60
  v_perm_b32 v57, v229, v225, s61
  v_perm_b32 v54, v230, v226, s60
  v_perm_b32 v58, v230, v226, s61
  v_perm_b32 v55, v231, v227, s60
  v_perm_b32 v59, v231, v227, s61
  v_dot2c_f32_bf16 v16, v52, v32
  v_dot2c_f32_bf16 v17, v56, v32
  v_dot2c_f32_bf16 v18, v53, v32
  v_dot2c_f32_bf16 v19, v57, v32
  v_dot2c_f32_bf16 v20, v54, v32
  v_dot2c_f32_bf16 v21, v58, v32
  v_dot2c_f32_bf16 v22, v55, v32
  v_dot2c_f32_bf16 v23, v59, v32
  s_waitcnt vmcnt(4)
  v_perm_b32 v52, v236, v232, s60
  v_perm_b32 v56, v236, v232, s61
  v_perm_b32 v53, v237, v233, s60
  v_perm_b32 v57, v237, v233, s61
  v_perm_b32 v54, v238, v234, s60
  v_perm_b32 v58, v238, v234, s61
  v_perm_b32 v55, v239, v235, s60
  v_perm_b32 v59, v239, v235, s61
  v_dot2c_f32_bf16 v16, v52, v33
  v_dot2c_f32_bf16 v17, v56, v33
  v_dot2c_f32_bf16 v18, v53, v33
  v_dot2c_f32_bf16 v19, v57, v33
  v_dot2c_f32_bf16 v20, v54, v33
  v_dot2c_f32_bf16 v21, v58, v33
  v_dot2c_f32_bf16 v22, v55, v33
  v_dot2c_f32_bf16 v23, v59, v33
  s_waitcnt vmcnt(2)
  v_perm_b32 v52, v244, v240, s60
  v_perm_b32 v56, v244, v240, s61
  v_perm_b32 v53, v245, v241, s60
  v_perm_b32 v57, v245, v241, s61
  v_perm_b32 v54, v246, v242, s60
  v_perm_b32 v58, v246, v242, s61
  v_perm_b32 v55, v247, v243, s60
  v_perm_b32 v59, v247, v243, s61
  v_dot2c_f32_bf16 v16, v52, v34
  v_dot2c_f32_bf16 v17, v56, v34
  v_dot2c_f32_bf16 v18, v53, v34
  v_dot2c_f32_bf16 v19, v57, v34
  v_dot2c_f32_bf16 v20, v54, v34
  v_dot2c_f32_bf16 v21, v58, v34
  v_dot2c_f32_bf16 v22, v55, v34
  v_dot2c_f32_bf16 v23, v59, v34
  s_waitcnt vmcnt(0)
  v_perm_b32 v52, v252, v248, s60
  v_perm_b32 v56, v252, v248, s61
  v_perm_b32 v53, v253, v249, s60
  v_perm_b32 v57, v253, v249, s61
  v_perm_b32 v54, v254, v250, s60
  v_perm_b32 v58, v254, v250, s61
  v_perm_b32 v55, v255, v251, s60
  v_perm_b32 v59, v255, v251, s61
  v_dot2c_f32_bf16 v16, v52, v35
  v_dot2c_f32_bf16 v17, v56, v35
  v_dot2c_f32_bf16 v18, v53, v35
  v_dot2c_f32_bf16 v19, v57, v35
  v_dot2c_f32_bf16 v20, v54, v35
  v_dot2c_f32_bf16 v21, v58, v35
  v_dot2c_f32_bf16 v22, v55, v35
  v_dot2c_f32_bf16 v23, v59, v35
  s_nop 3
  v_permlane32_swap_b32 v16, v20
  v_permlane32_swap_b32 v17, v21
  v_permlane32_swap_b32 v18, v22
  v_permlane32_swap_b32 v19, v23
  s_nop 1
  v_add_f32 v16, v16, v20
  v_add_f32 v17, v17, v21
  v_add_f32 v18, v18, v22
  v_add_f32 v19, v19, v23
  s_nop 1
  v_permlane16_swap_b32 v16, v18
  v_permlane16_swap_b32 v17, v19
  s_nop 1
  v_add_f32 v16, v16, v18
  v_add_f32 v17, v17, v19
  s_nop 1
  v_add_f32_dpp v16, v16, v16 row_ror:8 row_mask:0xf bank_mask:0xf
  v_add_f32_dpp v17, v17, v17 row_ror:8 row_mask:0xf bank_mask:0xf
  s_nop 1
  v_add_f32_dpp v16, v16, v16 row_ror:4 row_mask:0xf bank_mask:0xf
  v_add_f32_dpp v17, v17, v17 row_ror:4 row_mask:0xf bank_mask:0xf
  s_mov_b64 exec, s[62:63]
  ds_write_b64 v13, v[16:17] offset:22848
  s_mov_b64 exec, -1
  s_mul_i32 s70, s30, 896
  s_add_u32 s44, s4, s70
  s_addc_u32 s45, s5, 0
  s_mov_b32 s46, 896
  s_mul_i32 s57, s2, 2176
  s_add_u32 s57, s57, 262144
  s_mul_i32 s58, s2, 1792
  s_add_u32 s58, s58, 2097152
  s_waitcnt lgkmcnt(0)
  s_barrier
  ds_read_b64 v[16:17], v12 offset:22848
  ds_read_b64 v[18:19], v12 offset:22976
  ds_read_b64 v[20:21], v12 offset:23104
  ds_read_b64 v[22:23], v12 offset:23232
  s_waitcnt vmcnt(0)
  v_add_u32 v72, 0x10000, v72
  v_add_u32 v73, 0x10000, v73
  v_and_b32 v72, 0xffff0000, v72
  v_and_b32 v73, 0xffff0000, v73
  s_waitcnt lgkmcnt(0)
  v_add_f32 v16, v16, v18
  v_add_f32 v17, v17, v19
  v_add_f32 v20, v20, v22
  v_add_f32 v21, v21, v23
  v_add_f32 v16, v16, v20
  v_add_f32 v17, v17, v21
  v_cvt_pk_bf16_f32 v16, v16, 0
  v_cvt_pk_bf16_f32 v17, v17, 0
  v_or_b32 v72, v72, v16
  v_or_b32 v73, v73, v17
  s_mov_b64 exec, s[62:63]
  buffer_store_dwordx2 v[72:73], v12, s[40:43], s59 offen offset:0 sc1
  s_mov_b64 exec, -1
  buffer_store_dwordx4 v[48:51], v14, s[40:43], s57 offen offset:0 sc1
  buffer_store_dwordx4 v[48:51], v14, s[40:43], s57 offen offset:1024 sc1
  buffer_store_dwordx4 v[48:51], v14, s[40:43], s58 offen sc1
  s_mov_b32 s70, -1
  s_mov_b32 s71, 0xffff
  s_mov_b64 exec, s[70:71]
  buffer_store_dwordx4 v[48:51], v14, s[40:43], s58 offen offset:1024 sc1
  s_mov_b64 exec, 0xff
  buffer_store_dwordx4 v[48:51], v14, s[40:43], s57 offen offset:2048 sc1
  s_mov_b64 exec, -1
  s_cmp_lg_u32 s29, 0
  s_cbranch_scc1 L_notinit
  s_lshl_b32 s70, s28, 12
  s_add_u32 s70, s70, 65536
  s_mov_b64 exec, 1
  buffer_store_dword v15, v15, s[40:43], s70 offen sc1
  s_mov_b64 exec, -1
L_notinit:
  s_lshl_b32 s65, s30, 6
  s_add_u32 s65, s65, 128
  s_mov_b32 s68, 1
  s_mov_b32 s59, 0
  s_mov_b32 s66, 0x10000
  s_waitcnt vmcnt(0)
  s_atomic_add s68, s[24:25], s65
L_pollq:
  buffer_load_dwordx4 v[76:79], v11, s[40:43], s56 offen offset:0 sc1
  buffer_load_dwordx4 v[80:83], v11, s[40:43], s56 offen offset:16 sc1
  s_waitcnt vmcnt(0)
  v_xor_b32 v84, v64, v76
  v_xor_b32 v85, v65, v77
  v_xor_b32 v86, v66, v78
  v_xor_b32 v87, v67, v79
  v_xor_b32 v88, v68, v80
  v_xor_b32 v89, v69, v81
  v_xor_b32 v90, v70, v82
  v_xor_b32 v91, v71, v83
  v_min3_u32 v84, v84, v85, v86
  v_min3_u32 v87, v87, v88, v89
  v_min3_u32 v84, v84, v90, v91
  v_min_u32 v84, v84, v87
  v_cmp_gt_u32 vcc, s66, v84
  s_cbranch_vccz L_pollq_done
  s_mov_b64 exec, vcc
  s_add_u32 s59, s59, 1
  s_sleep 1
  s_cmp_lt_u32 s59, 4
  s_cbranch_scc1 L_pollq
  s_mov_b32 s70, 0
  s_atomic_add s70, s[24:25], s65 glc
  s_waitcnt lgkmcnt(0)
  s_cmp_ge_u32 s70, 128
  s_cselect_b32 s66, 0, s66
  s_cmp_lt_u32 s59, 200000
  s_cbranch_scc1 L_pollq
L_pollq_done:
  s_mov_b64 exec, -1
  v_perm_b32 v48, v77, v76, s60
  v_perm_b32 v49, v79, v78, s60
  v_perm_b32 v50, v81, v80, s60
  v_perm_b32 v51, v83, v82, s60
  ds_write_b128 v14, v[48:51] offset:0
  s_waitcnt lgkmcnt(0)
  s_barrier
  v_and_b32 v56, 1, v1
  v_lshlrev_b32 v56, 4, v56
  v_mov_b32 v57, 0xffff
  v_lshlrev_b32 v57, v56, v57
  v_bfe_u32 v56, v1, 1, 2
  v_cmp_eq_u32 vcc, 0, v56
  s_nop 1
  v_cndmask_b32 v4, 0, v57, vcc
  v_cmp_eq_u32 vcc, 1, v56
  s_nop 1
  v_cndmask_b32 v5, 0, v57, vcc
  v_cmp_eq_u32 vcc, 2, v56
  s_nop 1
  v_cndmask_b32 v6, 0, v57, vcc
  v_cmp_eq_u32 vcc, 3, v56
  s_nop 1
  v_cndmask_b32 v7, 0, v57, vcc
  s_and_b32 s66, s31, 7
  s_mul_i32 s66, s66, 14
  s_lshr_b32 s67, s31, 3
  s_add_u32 s66, s66, s67
  s_cmp_lt_u32 s31, 112
  s_cselect_b32 s59, 1605632, 0
  s_mov_b32 s48, s16
  s_mov_b32 s49, s17
  s_mov_b32 s50, s59
  s_mov_b32 s51, 0x00020000
  s_mov_b32 s36, s20
  s_mov_b32 s37, s21
  s_mov_b32 s38, 896
  s_mov_b32 s39, 0x00020000
  v_lshrrev_b32 v10, 1, v1
  v_and_b32 v11, 1, v1
  v_mul_u32_u24 v12, 28, v10
  v_mul_u32_u24 v13, 50176, v10
  v_lshl_add_u32 v13, v11, 4, v13
  buffer_load_dwordx4 v[32:35], v12, s[44:47], 0 offen
  buffer_load_dwordx3 v[36:38], v12, s[44:47], 0 offen offset:16
  buffer_load_dwordx4 v[40:43], v14, s[44:47], 0 offen
  buffer_load_dwordx4 v[44:47], v14, s[36:39], 0 offen
  s_lshl_b32 s56, s66, 5
  buffer_load_dwordx4 v[64:67], v13, s[48:51], s56 offen
  s_add_u32 s56, s56, 3584
  buffer_load_dwordx4 v[68:71], v13, s[48:51], s56 offen
  s_add_u32 s56, s56, 3584
  buffer_load_dwordx4 v[72:75], v13, s[48:51], s56 offen
  s_add_u32 s56, s56, 3584
  buffer_load_dwordx4 v[76:79], v13, s[48:51], s56 offen
  s_add_u32 s56, s56, 3584
  buffer_load_dwordx4 v[80:83], v13, s[48:51], s56 offen
  s_add_u32 s56, s56, 3584
  buffer_load_dwordx4 v[84:87], v13, s[48:51], s56 offen
  s_add_u32 s56, s56, 3584
  buffer_load_dwordx4 v[88:91], v13, s[48:51], s56 offen
  s_add_u32 s56, s56, 3584
  buffer_load_dwordx4 v[92:95], v13, s[48:51], s56 offen
  s_add_u32 s56, s56, 3584
  s_waitcnt vmcnt(0)
  buffer_load_dwordx4 v[96:99], v13, s[48:51], s56 offen
  s_add_u32 s56, s56, 3584
  buffer_load_dwordx4 v[100:103], v13, s[48:51], s56 offen
  s_add_u32 s56, s56, 3584
  buffer_load_dwordx4 v[104:107], v13, s[48:51], s56 offen
  s_add_u32 s56, s56, 3584
  buffer_load_dwordx4 v[108:111], v13, s[48:51], s56 offen
  s_add_u32 s56, s56, 3584
  buffer_load_dwordx4 v[112:115], v13, s[48:51], s56 offen
  s_add_u32 s56, s56, 3584
  buffer_load_dwordx4 v[116:119], v13, s[48:51], s56 offen
  s_add_u32 s56, s56, 3584
  v_mov_b32 v16, 0
  v_mov_b32 v17, 0
  v_mov_b32 v18, 0
  v_mov_b32 v19, 0
  v_mov_b32 v20, 0
  v_mov_b32 v21, 0
  v_mov_b32 v22, 0
  v_mov_b32 v23, 0
  s_waitcnt vmcnt(12)
  v_perm_b32 v52, v68, v64, s60
  v_perm_b32 v56, v68, v64, s61
  v_perm_b32 v53, v69, v65, s60
  v_perm_b32 v57, v69, v65, s61
  v_perm_b32 v54, v70, v66, s60
  v_perm_b32 v58, v70, v66, s61
  v_perm_b32 v55, v71, v67, s60
  v_perm_b32 v59, v71, v67, s61
  v_dot2c_f32_bf16 v16, v52, v32
  v_dot2c_f32_bf16 v17, v56, v32
  v_dot2c_f32_bf16 v18, v53, v32
  v_dot2c_f32_bf16 v19, v57, v32
  v_dot2c_f32_bf16 v20, v54, v32
  v_dot2c_f32_bf16 v21, v58, v32
  v_dot2c_f32_bf16 v22, v55, v32
  v_dot2c_f32_bf16 v23, v59, v32
  s_waitcnt vmcnt(10)
  v_perm_b32 v52, v76, v72, s60
  v_perm_b32 v56, v76, v72, s61
  v_perm_b32 v53, v77, v73, s60
  v_perm_b32 v57, v77, v73, s61
  v_perm_b32 v54, v78, v74, s60
  v_perm_b32 v58, v78, v74, s61
  v_perm_b32 v55, v79, v75, s60
  v_perm_b32 v59, v79, v75, s61
  v_dot2c_f32_bf16 v16, v52, v33
  v_dot2c_f32_bf16 v17, v56, v33
  v_dot2c_f32_bf16 v18, v53, v33
  v_dot2c_f32_bf16 v19, v57, v33
  v_dot2c_f32_bf16 v20, v54, v33
  v_dot2c_f32_bf16 v21, v58, v33
  v_dot2c_f32_bf16 v22, v55, v33
  v_dot2c_f32_bf16 v23, v59, v33
  s_waitcnt vmcnt(8)
  v_perm_b32 v52, v84, v80, s60
  v_perm_b32 v56, v84, v80, s61
  v_perm_b32 v53, v85, v81, s60
  v_perm_b32 v57, v85, v81, s61
  v_perm_b32 v54, v86, v82, s60
  v_perm_b32 v58, v86, v82, s61
  v_perm_b32 v55, v87, v83, s60
  v_perm_b32 v59, v87, v83, s61
  v_dot2c_f32_bf16 v16, v52, v34
  v_dot2c_f32_bf16 v17, v56, v34
  v_dot2c_f32_bf16 v18, v53, v34
  v_dot2c_f32_bf16 v19, v57, v34
  v_dot2c_f32_bf16 v20, v54, v34
  v_dot2c_f32_bf16 v21, v58, v34
  v_dot2c_f32_bf16 v22, v55, v34
  v_dot2c_f32_bf16 v23, v59, v34
  s_waitcnt vmcnt(6)
  v_perm_b32 v52, v92, v88, s60
  v_perm_b32 v56, v92, v88, s61
  v_perm_b32 v53, v93, v89, s60
  v_perm_b32 v57, v93, v89, s61
  v_perm_b32 v54, v94, v90, s60
  v_perm_b32 v58, v94, v90, s61
  v_perm_b32 v55, v95, v91, s60
  v_perm_b32 v59, v95, v91, s61
  v_dot2c_f32_bf16 v16, v52, v35
  v_dot2c_f32_bf16 v17, v56, v35
  v_dot2c_f32_bf16 v18, v53, v35
  v_dot2c_f32_bf16 v19, v57, v35
  v_dot2c_f32_bf16 v20, v54, v35
  v_dot2c_f32_bf16 v21, v58, v35
  v_dot2c_f32_bf16 v22, v55, v35
  v_dot2c_f32_bf16 v23, v59, v35
  s_waitcnt vmcnt(4)
  v_perm_b32 v52, v100, v96, s60
  v_perm_b32 v56, v100, v96, s61
  v_perm_b32 v53, v101, v97, s60
  v_perm_b32 v57, v101, v97, s61
  v_perm_b32 v54, v102, v98, s60
  v_perm_b32 v58, v102, v98, s61
  v_perm_b32 v55, v103, v99, s60
  v_perm_b32 v59, v103, v99, s61
  v_dot2c_f32_bf16 v16, v52, v36
  v_dot2c_f32_bf16 v17, v56, v36
  v_dot2c_f32_bf16 v18, v53, v36
  v_dot2c_f32_bf16 v19, v57, v36
  v_dot2c_f32_bf16 v20, v54, v36
  v_dot2c_f32_bf16 v21, v58, v36
  v_dot2c_f32_bf16 v22, v55, v36
  v_dot2c_f32_bf16 v23, v59, v36
  s_waitcnt vmcnt(2)
  v_perm_b32 v52, v108, v104, s60
  v_perm_b32 v56, v108, v104, s61
  v_perm_b32 v53, v109, v105, s60
  v_perm_b32 v57, v109, v105, s61
  v_perm_b32 v54, v110, v106, s60
  v_perm_b32 v58, v110, v106, s61
  v_perm_b32 v55, v111, v107, s60
  v_perm_b32 v59, v111, v107, s61
  v_dot2c_f32_bf16 v16, v52, v37
  v_dot2c_f32_bf16 v17, v56, v37
  v_dot2c_f32_bf16 v18, v53, v37
  v_dot2c_f32_bf16 v19, v57, v37
  v_dot2c_f32_bf16 v20, v54, v37
  v_dot2c_f32_bf16 v21, v58, v37
  v_dot2c_f32_bf16 v22, v55, v37
  v_dot2c_f32_bf16 v23, v59, v37
  s_waitcnt vmcnt(0)
  v_perm_b32 v52, v116, v112, s60
  v_perm_b32 v56, v116, v112, s61
  v_perm_b32 v53, v117, v113, s60
  v_perm_b32 v57, v117, v113, s61
  v_perm_b32 v54, v118, v114, s60
  v_perm_b32 v58, v118, v114, s61
  v_perm_b32 v55, v119, v115, s60
  v_perm_b32 v59, v119, v115, s61
  v_dot2c_f32_bf16 v16, v52, v38
  v_dot2c_f32_bf16 v17, v56, v38
  v_dot2c_f32_bf16 v18, v53, v38
  v_dot2c_f32_bf16 v19, v57, v38
  v_dot2c_f32_bf16 v20, v54, v38
  v_dot2c_f32_bf16 v21, v58, v38
  v_dot2c_f32_bf16 v22, v55, v38
  v_dot2c_f32_bf16 v23, v59, v38
  s_nop 3
  v_permlane32_swap_b32 v16, v20
  v_permlane32_swap_b32 v17, v21
  v_permlane32_swap_b32 v18, v22
  v_permlane32_swap_b32 v19, v23
  s_nop 1
  v_add_f32 v16, v16, v20
  v_add_f32 v17, v17, v21
  v_add_f32 v18, v18, v22
  v_add_f32 v19, v19, v23
  s_nop 1
  v_permlane16_swap_b32 v16, v18
  v_permlane16_swap_b32 v17, v19
  s_nop 1
  v_add_f32 v16, v16, v18
  v_add_f32 v17, v17, v19
  s_nop 1
  v_add_f32_dpp v16, v16, v16 row_ror:8 row_mask:0xf bank_mask:0xf
  v_add_f32_dpp v17, v17, v17 row_ror:8 row_mask:0xf bank_mask:0xf
  s_nop 1
  v_add_f32_dpp v16, v16, v16 row_ror:4 row_mask:0xf bank_mask:0xf
  v_add_f32_dpp v17, v17, v17 row_ror:4 row_mask:0xf bank_mask:0xf
  s_nop 1
  v_add_f32_dpp v16, v16, v16 row_ror:2 row_mask:0xf bank_mask:0xf
  v_add_f32_dpp v17, v17, v17 row_ror:2 row_mask:0xf bank_mask:0xf
  s_mov_b32 s59, 0xbfb8aa3b
  v_cvt_pk_bf16_f32 v16, 0, v16
  v_cvt_pk_bf16_f32 v17, 0, v17
  v_mul_f32 v18, s59, v16
  v_mul_f32 v19, s59, v17
  v_exp_f32 v18, v18
  v_exp_f32 v19, v19
  s_nop 0
  v_add_f32 v18, 1.0, v18
  v_add_f32 v19, 1.0, v19
  v_rcp_f32 v18, v18
  v_rcp_f32 v19, v19
  s_nop 0
  v_mul_f32 v16, v16, v18
  v_mul_f32 v17, v17, v19
  v_cvt_pk_bf16_f32 v16, v16, v16
  v_cvt_pk_bf16_f32 v17, v17, v17
  v_lshlrev_b32 v12, 5, v11
  v_lshl_add_u32 v12, v9, 3, v12
  s_mov_b32 s62, 0x00030003
  s_mov_b32 s63, 0x00030003
  s_mov_b64 exec, s[62:63]
  ds_write_b64 v12, v[16:17] offset:22592
  s_mov_b64 exec, -1
  v_lshlrev_b32 v52, 16, v40
  v_lshlrev_b32 v53, 16, v44
  v_and_b32 v54, 0xffff0000, v40
  v_and_b32 v55, 0xffff0000, v44
  v_mul_f32 v52, v52, v53
  v_mul_f32 v54, v54, v55
  v_cvt_pk_bf16_f32 v52, 0, v52
  v_cvt_pk_bf16_f32 v54, 0, v54
  v_add_f32 v56, v52, v54
  v_lshlrev_b32 v52, 16, v41
  v_lshlrev_b32 v53, 16, v45
  v_and_b32 v54, 0xffff0000, v41
  v_and_b32 v55, 0xffff0000, v45
  v_mul_f32 v52, v52, v53
  v_mul_f32 v54, v54, v55
  v_cvt_pk_bf16_f32 v52, 0, v52
  v_cvt_pk_bf16_f32 v54, 0, v54
  v_add_f32 v56, v56, v52
  v_add_f32 v56, v56, v54
  v_lshlrev_b32 v52, 16, v42
  v_lshlrev_b32 v53, 16, v46
  v_and_b32 v54, 0xffff0000, v42
  v_and_b32 v55, 0xffff0000, v46
  v_mul_f32 v52, v52, v53
  v_mul_f32 v54, v54, v55
  v_cvt_pk_bf16_f32 v52, 0, v52
  v_cvt_pk_bf16_f32 v54, 0, v54
  v_add_f32 v56, v56, v52
  v_add_f32 v56, v56, v54
  v_lshlrev_b32 v52, 16, v43
  v_lshlrev_b32 v53, 16, v47
  v_and_b32 v54, 0xffff0000, v43
  v_and_b32 v55, 0xffff0000, v47
  v_mul_f32 v52, v52, v53
  v_mul_f32 v54, v54, v55
  v_cvt_pk_bf16_f32 v52, 0, v52
  v_cvt_pk_bf16_f32 v54, 0, v54
  v_add_f32 v56, v56, v52
  v_add_f32 v56, v56, v54
  s_nop 1
  v_add_f32_dpp v56, v56, v56 row_ror:8 row_mask:0xf bank_mask:0xf
  s_nop 1
  v_add_f32_dpp v56, v56, v56 row_ror:4 row_mask:0xf bank_mask:0xf
  s_nop 1
  v_add_f32_dpp v56, v56, v56 row_ror:2 row_mask:0xf bank_mask:0xf
  s_nop 1
  v_add_f32_dpp v56, v56, v56 row_ror:1 row_mask:0xf bank_mask:0xf
  v_mov_b32 v57, v56
  s_nop 1
  v_permlane32_swap_b32 v57, v56
  s_nop 1
  v_add_f32 v56, v56, v57
  v_mov_b32 v57, v56
  s_nop 1
  v_permlane16_swap_b32 v57, v56
  s_nop 1
  v_add_f32 v56, v56, v57
  v_cvt_pk_bf16_f32 v56, 0, v56
  v_mul_f32 v56, s59, v56
  v_exp_f32 v56, v56
  s_nop 0
  v_add_f32 v56, 1.0, v56
  v_rcp_f32 v56, v56
  s_nop 0
  v_cvt_pk_bf16_f32 v2, 0, v56
  v_sub_f32 v3, 1.0, v2
  v_cvt_pk_bf16_f32 v3, 0, v3
  v_mov_b32 v16, 0
  ds_write_b64 v16, v[2:3] offset:22656
  s_and_b32 s69, s31, 7
  s_mul_i32 s69, s69, 14
  s_lshr_b32 s67, s31, 3
  s_add_u32 s69, s69, s67
  s_mul_i32 s69, s69, 14336
  s_cmp_lt_u32 s31, 112
  s_cselect_b32 s46, 1605632, 0
  s_mov_b32 s44, s18
  s_mov_b32 s45, s19
  s_mov_b32 s47, 0x00020000
  s_mov_b32 s48, s12
  s_mov_b32 s49, s13
  s_mov_b32 s50, 3670016
  s_mov_b32 s51, 0x00020000
  s_lshl_b32 s64, s3, 8
  s_add_u32 s69, s69, s64
  s_mul_i32 s67, s31, 28672
  s_add_u32 s67, s67, s64
  s_add_u32 s68, s67, 3584
  s_lshl_b32 s64, s64, 1
  s_mul_i32 s52, s2, 1792
  s_add_u32 s64, s64, s52
  s_add_u32 s64, s64, 2097152
  s_cmp_eq_u32 s3, 3
  s_cselect_b32 s52, 0x00ff00ff, -1
  s_mov_b32 s53, 0
  v_mul_u32_u24 v54, 3584, v9
  v_lshl_add_u32 v54, v8, 4, v54
  v_mul_u32_u24 v55, 7168, v9
  v_lshl_add_u32 v55, v8, 4, v55
  v_lshlrev_b32 v53, 5, v8
  v_lshl_add_u32 v53, v9, 4, v53
  v_lshlrev_b32 v52, 4, v9
  ds_read_b128 v[80:83], v52 offset:22592
  v_lshlrev_b32 v52, 1, v52
  s_waitcnt lgkmcnt(0)
  v_and_b32 v24, v80, v4
  v_and_b32 v25, v80, v5
  v_and_b32 v26, v80, v6
  v_and_b32 v27, v80, v7
  v_and_b32 v28, v81, v4
  v_and_b32 v29, v81, v5
  v_and_b32 v30, v81, v6
  v_and_b32 v31, v81, v7
  v_and_b32 v32, v82, v4
  v_and_b32 v33, v82, v5
  v_and_b32 v34, v82, v6
  v_and_b32 v35, v82, v7
  v_and_b32 v36, v83, v4
  v_and_b32 v37, v83, v5
  v_and_b32 v38, v83, v6
  v_and_b32 v39, v83, v7
  s_mov_b32 s59, 0x3db8aa3b
  v_lshlrev_b32 v10, 5, v1
  v_lshrrev_b32 v11, 5, v1
  v_lshlrev_b32 v11, 3, v11
  v_lshrrev_b32 v15, 2, v1
  v_mul_u32_u24 v15, 144, v15
  v_and_b32 v12, 3, v1
  v_lshl_add_u32 v15, v12, 5, v15
  v_mul_u32_u24 v12, 2176, v8
  v_lshl_add_u32 v13, v9, 5, v12
  s_mul_i32 s60, s28, 34816
  s_add_u32 s60, s60, 262144
  s_lshr_b32 s66, s29, 3
  s_lshl_b32 s66, s66, 3
  s_add_u32 s66, s66, s60
  v_lshlrev_b32 v10, 4, v1
  v_mov_b32 v11, 0
  s_mul_i32 s61, s29, 128
  s_add_u32 s60, s60, s61
  v_lshlrev_b32 v14, 5, v9
  s_lshl_b32 s54, 0x00010001, s29
  s_mov_b32 s55, s54
  s_and_b32 s61, s29, 7
  s_lshl_b32 s61, s61, 5
  v_lshl_add_u32 v21, v9, 3, s61
  s_mov_b32 s32, s22
  s_mov_b32 s33, s23
  s_mov_b32 s34, 1792
  s_mov_b32 s35, 0x00020000
  s_mul_i32 s73, s30, 896
  s_lshl_b32 s70, s31, 5
  s_add_u32 s73, s73, s70
  s_cmp_lt_u32 s31, 28
  s_cselect_b32 s34, 1792, 0
  s_cselect_b32 s73, s73, 0
  s_mov_b64 exec, 1
  buffer_load_dword v200, v16, s[32:35], s73 offen
  buffer_load_dword v201, v16, s[40:43], s64 offen sc1
  buffer_load_dword v202, v16, s[40:43], s57 offen sc1
  buffer_load_dword v203, v54, s[44:47], s69 offen
  buffer_load_dword v204, v55, s[48:51], s67 offen
  s_mov_b64 exec, -1
  s_mov_b32 s56, 200000
L_pollg:
  s_mov_b32 s70, 0
  s_atomic_add s70, s[24:25], s65 glc
  s_waitcnt lgkmcnt(0)
  s_cmp_ge_u32 s70, 128
  s_cbranch_scc1 L_pollg_done
  s_sleep 16
  s_sub_u32 s56, s56, 1
  s_cmp_lg_u32 s56, 0
  s_cbranch_scc1 L_pollg
L_pollg_done:
  s_lshl_b32 s74, s28, 12
  s_add_u32 s74, s74, 65536
  s_add_u32 s74, s26, s74
  s_addc_u32 s75, s27, 0
  s_mov_b32 s71, 0
  s_mov_b32 s72, 0
  v_mov_b32 v16, 0
  s_mov_b32 s56, 6400000
L_tk:
  ds_read_b32 v17, v16 offset:23360
  s_waitcnt lgkmcnt(0)
  v_readfirstlane_b32 s70, v17
  s_cmp_gt_u32 s70, s72
  s_cbranch_scc1 L_tk_fetch
  s_sleep 2
  s_sub_u32 s56, s56, 1
  s_cmp_lg_u32 s56, 0
  s_cbranch_scc1 L_tk
  s_branch L_tk_done
L_tk_fetch:
  s_mov_b32 s70, 1
  s_atomic_add s70, s[74:75], 0 glc
  v_mov_b32 v17, s71
  s_waitcnt lgkmcnt(0)
  v_mov_b32 v20, s70
  s_add_u32 s71, s71, 4
  s_add_u32 s72, s72, 3
  ds_write_b32 v17, v20 offset:23424
  s_cmp_lt_u32 s70, 35
  s_cbranch_scc1 L_tk
  v_mov_b32 v17, s71
  v_mov_b32 v20, 0x10000
  ds_write_b32 v17, v20 offset:23424
L_tk_done:
  s_mov_b64 exec, 1
  buffer_load_dword v200, v16, s[32:35], s73 offen
  buffer_load_dword v201, v16, s[40:43], s64 offen sc1
  buffer_load_dword v202, v16, s[40:43], s57 offen sc1
  buffer_load_dword v203, v54, s[44:47], s69 offen
  buffer_load_dword v204, v55, s[48:51], s67 offen
  s_mov_b64 exec, -1
  s_waitcnt lgkmcnt(0)
  s_barrier
  ds_read_b128 v[40:43], v11 offset:22528
  ds_read_b128 v[44:47], v11 offset:22544
  ds_read_b128 v[48:51], v11 offset:22560
  ds_read_b128 v[64:67], v10 offset:16384
  ds_read_b128 v[68:71], v10 offset:17408
  ds_read_b128 v[72:75], v10 offset:18432
  ds_read_b128 v[76:79], v10 offset:19456
  ds_read_b128 v[80:83], v10 offset:20480
  ds_read_b128 v[84:87], v10 offset:21504
  s_waitcnt lgkmcnt(6)
  v_max3_f32 v16, v40, v44, v48
  v_max3_f32 v18, v42, v46, v50
  v_sub_f32 v40, v40, v16
  v_sub_f32 v42, v42, v18
  v_sub_f32 v44, v44, v16
  v_sub_f32 v46, v46, v18
  v_sub_f32 v48, v48, v16
  v_sub_f32 v50, v50, v18
  v_mul_f32 v40, s59, v40
  v_mul_f32 v42, s59, v42
  v_mul_f32 v44, s59, v44
  v_mul_f32 v46, s59, v46
  v_mul_f32 v48, s59, v48
  v_mul_f32 v50, s59, v50
  v_exp_f32 v40, v40
  v_exp_f32 v42, v42
  v_exp_f32 v44, v44
  v_exp_f32 v46, v46
  v_exp_f32 v48, v48
  v_exp_f32 v50, v50
  s_waitcnt lgkmcnt(0)
  v_mul_f32 v64, v40, v64
  v_mul_f32 v65, v40, v65
  v_mul_f32 v66, v40, v66
  v_mul_f32 v67, v40, v67
  v_fmac_f32 v64, v44, v72
  v_fmac_f32 v65, v44, v73
  v_fmac_f32 v66, v44, v74
  v_fmac_f32 v67, v44, v75
  v_fmac_f32 v64, v48, v80
  v_fmac_f32 v65, v48, v81
  v_fmac_f32 v66, v48, v82
  v_fmac_f32 v67, v48, v83
  buffer_store_dwordx4 v[64:67], v10, s[40:43], s57 offen offset:0 sc1
  v_mul_f32 v68, v42, v68
  v_mul_f32 v69, v42, v69
  v_mul_f32 v70, v42, v70
  v_mul_f32 v71, v42, v71
  v_fmac_f32 v68, v46, v76
  v_fmac_f32 v69, v46, v77
  v_fmac_f32 v70, v46, v78
  v_fmac_f32 v71, v46, v79
  v_fmac_f32 v68, v50, v84
  v_fmac_f32 v69, v50, v85
  v_fmac_f32 v70, v50, v86
  v_fmac_f32 v71, v50, v87
  buffer_store_dwordx4 v[68:71], v10, s[40:43], s57 offen offset:1024 sc1
  v_mul_f32 v17, v40, v41
  v_mul_f32 v19, v42, v43
  v_fmac_f32 v17, v44, v45
  v_fmac_f32 v19, v46, v47
  v_fmac_f32 v17, v48, v49
  v_fmac_f32 v19, v50, v51
  s_mov_b64 exec, 1
  buffer_store_dwordx4 v[16:19], v11, s[40:43], s57 offen offset:2048 sc1
  s_nop 0
  s_mov_b64 exec, -1
  s_barrier
  s_mov_b32 s56, 200000
  s_andn2_b64 exec, -1, s[54:55]
  buffer_load_dwordx4 v[72:75], v13, s[40:43], s60 offen sc1
  buffer_load_dwordx4 v[76:79], v13, s[40:43], s60 offen offset:16 sc1
  buffer_load_dwordx2 v[80:81], v12, s[40:43], s66 offen offset:2048 sc1
  s_mov_b32 s62, 0x00ff00ff
  s_mov_b32 s63, 0x00ff00ff
  s_mov_b64 exec, s[62:63]
  buffer_load_dwordx4 v[160:163], v54, s[44:47], s69 offen offset:0
  buffer_load_dwordx4 v[164:167], v54, s[44:47], s69 offen offset:896
  buffer_load_dwordx4 v[168:171], v54, s[44:47], s69 offen offset:1792
  buffer_load_dwordx4 v[172:175], v54, s[44:47], s69 offen offset:2688
  buffer_load_dwordx4 v[128:131], v55, s[48:51], s67 offen offset:0
  buffer_load_dwordx4 v[132:135], v55, s[48:51], s67 offen offset:896
  buffer_load_dwordx4 v[136:139], v55, s[48:51], s67 offen offset:1792
  buffer_load_dwordx4 v[140:143], v55, s[48:51], s67 offen offset:2688
  buffer_load_dwordx4 v[144:147], v55, s[48:51], s68 offen offset:0
  buffer_load_dwordx4 v[148:151], v55, s[48:51], s68 offen offset:896
  buffer_load_dwordx4 v[152:155], v55, s[48:51], s68 offen offset:1792
  buffer_load_dwordx4 v[156:159], v55, s[48:51], s68 offen offset:2688
  s_mov_b64 exec, -1
  s_cmp_lt_u32 s29, 8
  s_cbranch_scc1 L_ownh0
  v_mov_b32 v64, v68
  v_mov_b32 v65, v69
  v_mov_b32 v66, v70
  v_mov_b32 v67, v71
  v_mov_b32 v16, v18
  v_mov_b32 v17, v19
L_ownh0:
  ds_bpermute_b32 v88, v21, v64
  ds_bpermute_b32 v92, v21, v64 offset:4
  ds_bpermute_b32 v89, v21, v65
  ds_bpermute_b32 v93, v21, v65 offset:4
  ds_bpermute_b32 v90, v21, v66
  ds_bpermute_b32 v94, v21, v66 offset:4
  ds_bpermute_b32 v91, v21, v67
  ds_bpermute_b32 v95, v21, v67 offset:4
  v_mov_b32 v96, v16
  v_mov_b32 v97, v17
  s_mov_b64 exec, s[54:55]
  s_waitcnt vmcnt(12) lgkmcnt(0)
  v_mov_b32 v72, v88
  v_mov_b32 v73, v89
  v_mov_b32 v74, v90
  v_mov_b32 v75, v91
  v_mov_b32 v76, v92
  v_mov_b32 v77, v93
  v_mov_b32 v78, v94
  v_mov_b32 v79, v95
  v_mov_b32 v80, v96
  v_mov_b32 v81, v97
  s_mov_b64 exec, -1
  s_branch L_poll1_chk
L_poll1:
  buffer_load_dwordx4 v[72:75], v13, s[40:43], s60 offen sc1
  buffer_load_dwordx4 v[76:79], v13, s[40:43], s60 offen offset:16 sc1
  buffer_load_dwordx2 v[80:81], v12, s[40:43], s66 offen offset:2048 sc1
  s_waitcnt vmcnt(0)
L_poll1_chk:
  v_max3_u32 v18, v72, v73, v74
  v_max3_u32 v19, v75, v76, v77
  v_max3_u32 v18, v18, v78, v79
  v_max3_u32 v19, v19, v80, v81
  v_max_u32 v18, v18, v19
  v_cmp_eq_u32 vcc, -1, v18
  s_cbranch_vccz L_poll1_done
  s_mov_b64 exec, vcc
  s_bcnt1_i32_b64 s61, vcc
  s_cmp_le_u32 s61, 28
  s_cbranch_scc1 L_poll1_fast
  s_sleep 16
L_poll1_fast:
  s_sleep 1
  s_sub_u32 s56, s56, 1
  s_cmp_lg_u32 s56, 0
  s_cbranch_scc1 L_poll1
L_poll1_done:
  s_mov_b64 exec, -1
  v_max_f32_dpp v18, v80, v80 row_ror:8 row_mask:0xf bank_mask:0xf
  s_nop 1
  v_max_f32_dpp v18, v18, v18 row_ror:4 row_mask:0xf bank_mask:0xf
  s_nop 1
  v_max_f32_dpp v18, v18, v18 row_ror:2 row_mask:0xf bank_mask:0xf
  s_nop 1
  v_max_f32_dpp v18, v18, v18 row_ror:1 row_mask:0xf bank_mask:0xf
  v_sub_f32 v18, v80, v18
  v_mul_f32 v18, s59, v18
  v_exp_f32 v18, v18
  s_nop 0
  v_mul_f32 v80, v18, v81
  v_mul_f32 v72, v18, v72
  v_mul_f32 v73, v18, v73
  v_mul_f32 v74, v18, v74
  v_mul_f32 v75, v18, v75
  v_mul_f32 v76, v18, v76
  v_mul_f32 v77, v18, v77
  v_mul_f32 v78, v18, v78
  v_mul_f32 v79, v18, v79
  v_add_f32_dpp v80, v80, v80 row_ror:8 row_mask:0xf bank_mask:0xf
  v_add_f32_dpp v72, v72, v72 row_ror:8 row_mask:0xf bank_mask:0xf
  v_add_f32_dpp v73, v73, v73 row_ror:8 row_mask:0xf bank_mask:0xf
  v_add_f32_dpp v74, v74, v74 row_ror:8 row_mask:0xf bank_mask:0xf
  v_add_f32_dpp v75, v75, v75 row_ror:8 row_mask:0xf bank_mask:0xf
  v_add_f32_dpp v76, v76, v76 row_ror:8 row_mask:0xf bank_mask:0xf
  v_add_f32_dpp v77, v77, v77 row_ror:8 row_mask:0xf bank_mask:0xf
  v_add_f32_dpp v78, v78, v78 row_ror:8 row_mask:0xf bank_mask:0xf
  v_add_f32_dpp v79, v79, v79 row_ror:8 row_mask:0xf bank_mask:0xf
  v_add_f32_dpp v80, v80, v80 row_ror:4 row_mask:0xf bank_mask:0xf
  v_add_f32_dpp v72, v72, v72 row_ror:4 row_mask:0xf bank_mask:0xf
  v_add_f32_dpp v73, v73, v73 row_ror:4 row_mask:0xf bank_mask:0xf
  v_add_f32_dpp v74, v74, v74 row_ror:4 row_mask:0xf bank_mask:0xf
  v_add_f32_dpp v75, v75, v75 row_ror:4 row_mask:0xf bank_mask:0xf
  v_add_f32_dpp v76, v76, v76 row_ror:4 row_mask:0xf bank_mask:0xf
  v_add_f32_dpp v77, v77, v77 row_ror:4 row_mask:0xf bank_mask:0xf
  v_add_f32_dpp v78, v78, v78 row_ror:4 row_mask:0xf bank_mask:0xf
  v_add_f32_dpp v79, v79, v79 row_ror:4 row_mask:0xf bank_mask:0xf
  v_add_f32_dpp v80, v80, v80 row_ror:2 row_mask:0xf bank_mask:0xf
  v_add_f32_dpp v72, v72, v72 row_ror:2 row_mask:0xf bank_mask:0xf
  v_add_f32_dpp v73, v73, v73 row_ror:2 row_mask:0xf bank_mask:0xf
  v_add_f32_dpp v74, v74, v74 row_ror:2 row_mask:0xf bank_mask:0xf
  v_add_f32_dpp v75, v75, v75 row_ror:2 row_mask:0xf bank_mask:0xf
  v_add_f32_dpp v76, v76, v76 row_ror:2 row_mask:0xf bank_mask:0xf
  v_add_f32_dpp v77, v77, v77 row_ror:2 row_mask:0xf bank_mask:0xf
  v_add_f32_dpp v78, v78, v78 row_ror:2 row_mask:0xf bank_mask:0xf
  v_add_f32_dpp v79, v79, v79 row_ror:2 row_mask:0xf bank_mask:0xf
  v_add_f32_dpp v80, v80, v80 row_ror:1 row_mask:0xf bank_mask:0xf
  v_add_f32_dpp v72, v72, v72 row_ror:1 row_mask:0xf bank_mask:0xf
  v_add_f32_dpp v73, v73, v73 row_ror:1 row_mask:0xf bank_mask:0xf
  v_add_f32_dpp v74, v74, v74 row_ror:1 row_mask:0xf bank_mask:0xf
  v_add_f32_dpp v75, v75, v75 row_ror:1 row_mask:0xf bank_mask:0xf
  v_add_f32_dpp v76, v76, v76 row_ror:1 row_mask:0xf bank_mask:0xf
  v_add_f32_dpp v77, v77, v77 row_ror:1 row_mask:0xf bank_mask:0xf
  v_add_f32_dpp v78, v78, v78 row_ror:1 row_mask:0xf bank_mask:0xf
  v_add_f32_dpp v79, v79, v79 row_ror:1 row_mask:0xf bank_mask:0xf
  v_rcp_f32 v80, v80
  s_nop 0
  v_mul_f32 v72, v80, v72
  v_mul_f32 v73, v80, v73
  v_mul_f32 v74, v80, v74
  v_mul_f32 v75, v80, v75
  v_mul_f32 v76, v80, v76
  v_mul_f32 v77, v80, v77
  v_mul_f32 v78, v80, v78
  v_mul_f32 v79, v80, v79
  v_cvt_pk_bf16_f32 v72, v72, v72
  v_cvt_pk_bf16_f32 v73, v73, v73
  v_cvt_pk_bf16_f32 v74, v74, v74
  v_cvt_pk_bf16_f32 v75, v75, v75
  v_cvt_pk_bf16_f32 v76, v76, v76
  v_cvt_pk_bf16_f32 v77, v77, v77
  v_cvt_pk_bf16_f32 v78, v78, v78
  v_cvt_pk_bf16_f32 v79, v79, v79
  s_mov_b32 s62, 0x00010001
  s_mov_b32 s63, 0x00010001
  s_mov_b64 exec, s[62:63]
  ds_write_b128 v14, v[72:75] offset:22720
  ds_write_b128 v14, v[76:79] offset:22736
  s_mov_b64 exec, -1
  s_waitcnt lgkmcnt(0)
  s_branch L_out
L_svc_end:
L_end:
  s_endpgm
.section .rodata,"a"
.p2align 6
.amdhsa_kernel gated_mix__gqa_block_cached__dense_activation_silu__decode_kernel
  .amdhsa_next_free_vgpr 256
  .amdhsa_next_free_sgpr 96
  .amdhsa_accum_offset 256
  .amdhsa_group_segment_fixed_size 0
  .amdhsa_kernarg_size 96
  .amdhsa_user_sgpr_count 2
  .amdhsa_user_sgpr_kernarg_segment_ptr 1
  .amdhsa_system_sgpr_workgroup_id_x 1
.end_amdhsa_kernel
```
